```python
import torch

def _softmax(x, axis=-1):
    return torch.softmax(x, dim=axis)
def _gelu(x):
    return torch.nn.functional.gelu(x, approximate="tanh")
def _silu(x):
    return torch.nn.functional.silu(x)
def _sigmoid(x):
    return torch.sigmoid(x)
def _layernorm(x, axis=-1, eps=1e-5):
    m = x.mean(dim=axis, keepdim=True)
    v = x.var(dim=axis, keepdim=True, unbiased=False)
    return (x - m) / torch.sqrt(v + eps)
def _scatter_add(tgt, idx, src, axis=0):
    return tgt.clone().index_add_(axis, idx, src)
def _segment_sum(src, seg, n):
    out = torch.zeros((n,) + src.shape[1:], dtype=src.dtype)
    return out.index_add_(0, seg, src)
def _pad(x, pw):
    flat = tuple(v for pair in reversed(pw) for v in pair)
    return torch.nn.functional.pad(x, flat)

kernel_name = 'sequential_preLN__compressed_kv_cla__glu_gated_swiglu__decode'

def setup_inputs():

    _w = (lambda a: (lambda t: t.to(torch.bfloat16) if t.is_floating_point() else t)(torch.as_tensor(a)))
    def _A_setup():
        B, H, Sq, Sk, D, M = 2, 32, 1, 8192, 128, 640
        Dc = 4 * D
        return {
            "x": _w((lambda *s: torch.randn(*s, dtype=torch.bfloat16) * 0.05)(B, Sq, M)),
            "c_kv": _w((lambda *s: torch.randn(*s, dtype=torch.bfloat16) * 0.8)(B, Sk, Dc)),
            "w_q": _w((lambda *s: torch.randn(*s, dtype=torch.bfloat16) * 1.6)(M, H, D) * (M ** -0.5)),
            "w_uk": _w((lambda *s: torch.randn(*s, dtype=torch.bfloat16) * 1.6)(Dc, H, D) * (Dc ** -0.5)),
            "w_uv": _w((lambda *s: torch.randn(*s, dtype=torch.bfloat16) * 0.8)(Dc, H, D) * (Dc ** -0.5)),
            "w_o": _w((lambda *s: torch.randn(*s, dtype=torch.bfloat16) * 0.8)(H, D, M) * ((H * D) ** -0.5)),
        }
    _A_in = _A_setup()

    def _B_setup():
        B, S, D, F = 2, 1, 640, 1728
        return {
            "x": _w((lambda *s: torch.randn(*s, dtype=torch.bfloat16) * 0.05)(B, S, D)),
            "w1": _w((lambda *s: torch.randn(*s, dtype=torch.bfloat16) * 0.2)(D, F) * (2.0 / D) ** 0.5),
            "w3": _w((lambda *s: torch.randn(*s, dtype=torch.bfloat16) * 0.2)(D, F) * (2.0 / D) ** 0.5),
            "w2": _w((lambda *s: torch.randn(*s, dtype=torch.bfloat16) * 0.2)(F, D) * (2.0 / F) ** 0.5),
        }
    _B_in = _B_setup()

    return {
        "A_x": _A_in["x"],
        "A_c_kv": _A_in["c_kv"],
        "A_w_q": _A_in["w_q"],
        "A_w_uk": _A_in["w_uk"],
        "A_w_uv": _A_in["w_uv"],
        "A_w_o": _A_in["w_o"],
        "B_x": _B_in["x"],
        "B_w1": _B_in["w1"],
        "B_w3": _B_in["w3"],
        "B_w2": _B_in["w2"],
    }

def reference(A_x, A_c_kv, A_w_q, A_w_uk, A_w_uv, A_w_o, B_x, B_w1, B_w3, B_w2):
    def _A_ref(x, c_kv, w_q, w_uk, w_uv, w_o):
        B, Sq, M = x.shape[0], x.shape[1], x.shape[2]
        Sk = c_kv.shape[1]
        H, D = w_q.shape[1], w_q.shape[2]
        q = torch.einsum("bqm,mhd->bhqd", x, w_q)
        k = torch.einsum("bkc,chd->bhkd", c_kv, w_uk)
        v = torch.einsum("bkc,chd->bhkd", c_kv, w_uv)
        scores = torch.einsum("bhqd,bhkd->bhqk", q, k) * (D ** -0.5)
        off = Sk - Sq
        qi = torch.arange(Sq)[:, None]
        kj = torch.arange(Sk)[None, :]
        cmask = kj <= (qi + off)
        scores = torch.where(cmask[None, None], scores, -1e9)
        p = _softmax(scores, axis=-1)
        ctx = torch.einsum("bhqk,bhkd->bhqd", p, v)
        return torch.einsum("bhqd,hdm->bqm", ctx, w_o)

    def _B_ref(x, w1, w3, w2):
        gate = torch.einsum("bsd,df->bsf", x, w1)
        up = torch.einsum("bsd,df->bsf", x, w3)
        h = _silu(gate) * up
        out = torch.einsum("bsf,fd->bsd", h, w2)
        return out

    x = A_x
    h = x + _A_ref(_layernorm(x, axis=-1), A_c_kv, A_w_q, A_w_uk, A_w_uv, A_w_o)
    h2 = h + _B_ref(_layernorm(h, axis=-1), B_w1, B_w3, B_w2)
    return h2
```

```asm
; @launch grid=(256,1,1) block=(512,1,1) lds=163840
.amdgcn_target "amdgcn-amd-amdhsa--gfx950"
.text
.globl sequential_preLN__compressed_kv_cla__glu_gated_swiglu__decode_kernel
.p2align 8
.type sequential_preLN__compressed_kv_cla__glu_gated_swiglu__decode_kernel,@function
sequential_preLN__compressed_kv_cla__glu_gated_swiglu__decode_kernel:
  s_cmp_ge_u32 s2, 256
  s_cbranch_scc1 L_end
  s_load_dwordx16 s[64:79], s[0:1], 0
  s_load_dwordx8 s[80:87], s[0:1], 64
  s_load_dwordx2 s[88:89], s[0:1], 96
  s_memrealtime s[90:91]
  v_lshrrev_b32 v4, 6, v0
  v_and_b32 v1, 63, v0
  v_readfirstlane_b32 s3, v4
  v_lshrrev_b32 v2, 4, v1
  v_and_b32 v3, 15, v1
  v_mov_b32 v192, 0
  v_mov_b32 v193, 1
  v_lshlrev_b32 v4, 2, v3
  ds_write_b32 v4, v192 offset:64
  s_and_b32 s4, s2, 7
  s_lshr_b32 s5, s2, 3
  s_and_b32 s6, s5, 15
  v_lshlrev_b32 v5, 4, v1
  v_mov_b32 v6, 2147483392
  v_mov_b32 v8, -1
  v_mov_b32 v9, -1
  v_mov_b32 v10, -1
  v_mov_b32 v11, -1
  v_cmp_eq_u32 vcc, 0, v1
  s_and_b32 s12, s5, 3
  s_lshl_b32 s12, s12, 3
  v_cndmask_b32 v7, v6, 0, vcc
  s_add_u32 s7, s4, s12
  s_lshr_b32 s8, s6, 2
  s_lshr_b32 s12, s6, 2
  s_lshl_b32 s12, s12, 3
  s_add_u32 s12, s12, s4
  s_cmp_lt_u32 s12, 27
  s_cselect_b32 s10, 1, 0
  s_and_b32 s11, s6, 3
  s_sub_u32 s14, s4, 3
  s_lshl_b32 s14, s14, 2
  s_add_u32 s14, s14, s11
  s_cmp_eq_u32 s10, 1
  s_cselect_b32 s9, s12, s14
  s_waitcnt lgkmcnt(0)
  s_cmp_ge_u32 s3, 4
  s_cbranch_scc1 L_e_hi
  s_or_b32 s14, s2, s3
  s_cmp_lg_u32 s14, 0
  s_cbranch_scc1 L_e_dma
  s_mov_b64 s[56:57], s[86:87]
  s_mov_b32 s58, 256
  s_mov_b32 s59, 0x20000
  s_or_b32 s90, s90, 1
  v_mov_b32 v14, s90
  v_mov_b32 v15, s91
  buffer_store_dwordx2 v[14:15], v7, s[56:59], 0 offen sc1
  s_branch L_e_dma
  L_e_hi:
  s_cmp_ge_u32 s3, 6
  s_cbranch_scc1 L_e_67
  s_sub_u32 s15, s3, 4
  s_mul_i32 s15, s15, 1280
  v_mul_u32_u24 v100, 20, v1
  s_mov_b64 s[16:17], s[64:65]
  s_mov_b32 s18, 2560
  s_mov_b32 s19, 0x20000
  buffer_load_dwordx4 v[8:11], v100, s[16:19], s15 offen
  buffer_load_dword v12, v100, s[16:19], s15 offen offset:16
  s_branch L_e_dma
  L_e_67:
  s_mov_b64 s[56:57], s[86:87]
  s_mov_b32 s58, 256
  s_mov_b32 s59, 0x20000
  s_mov_b64 s[60:61], s[88:89]
  s_mov_b32 s62, 16777216
  s_mov_b32 s63, 0x20000
  s_cmp_ge_u32 s5, 16
  s_cbranch_scc1 L_e_A67
  s_cmp_eq_u32 s3, 6
  s_cbranch_scc1 L_e_B6
  s_lshl_b32 s13, s4, 4
  s_add_u32 s13, s13, s6
  s_mul_i32 s13, s13, 5120
  s_add_u32 s13, s13, 2097152
  buffer_store_dwordx4 v[8:11], v5, s[60:63], s13 offen offset:0 sc1
  buffer_store_dwordx4 v[8:11], v5, s[60:63], s13 offen offset:1024 sc1
  buffer_store_dwordx4 v[8:11], v5, s[60:63], s13 offen offset:2048 sc1
  buffer_store_dwordx4 v[8:11], v5, s[60:63], s13 offen offset:3072 sc1
  s_add_u32 s13, s13, 4096
  buffer_store_dwordx4 v[8:11], v5, s[60:63], s13 offen sc1
  v_mul_u32_u24 v4, 2560, v2
  v_lshl_add_u32 v4, v3, 4, v4
  s_cmp_lt_u32 s6, 10
  s_cselect_b32 s15, 32, 0
  v_cmp_gt_u32 vcc, s15, v1
  s_mul_i32 s13, s4, 5120
  s_lshl_b32 s14, s6, 8
  v_cndmask_b32 v4, v6, v4, vcc
  s_add_u32 s13, s13, s14
  s_add_u32 s13, s13, 196608
  buffer_store_dwordx4 v[8:11], v4, s[60:63], s13 offen sc1
  s_branch L_e_dma
  L_e_B6:
  s_lshl_b32 s12, s7, 13
  s_add_u32 s12, s12, 524288
  v_lshlrev_b32 v4, 7, v1
  buffer_load_dword v14, v4, s[60:63], s12 offen nt
  v_lshrrev_b32 v4, 3, v1
  v_lshlrev_b32 v4, 8, v4
  v_and_b32 v12, 7, v1
  v_lshl_add_u32 v4, v12, 4, v4
  s_add_u32 s13, s12, 4096
  buffer_store_dwordx4 v[8:11], v4, s[60:63], s12 offen
  buffer_store_dwordx4 v[8:11], v4, s[60:63], s12 offen offset:2048
  buffer_store_dwordx4 v[8:11], v4, s[60:63], s13 offen
  buffer_store_dwordx4 v[8:11], v4, s[60:63], s13 offen offset:2048
  s_branch L_e_dma
  L_e_A67:
  s_cmp_eq_u32 s3, 7
  s_cbranch_scc1 L_e_A7
  s_branch L_e_dma
  L_e_A7:
  v_lshlrev_b32 v4, 7, v1
  v_cmp_gt_u32 vcc, 32, v1
  s_lshl_b32 s14, s4, 12
  s_lshl_b32 s15, s6, 3
  v_cndmask_b32 v4, v6, v4, vcc
  v_cndmask_b32 v12, v6, v5, vcc
  s_add_u32 s14, s14, s15
  s_add_u32 s14, s14, 327680
  buffer_store_dwordx2 v[8:9], v4, s[60:63], s14 offen sc1
  s_lshl_b32 s14, s4, 4
  s_add_u32 s14, s14, s6
  s_lshl_b32 s14, s14, 9
  s_add_u32 s14, s14, 65536
  buffer_store_dwordx4 v[8:11], v12, s[60:63], s14 offen sc1
  s_lshl_b32 s14, s6, 4
  s_add_u32 s14, s14, s4
  s_lshl_b32 s15, s14, 10
  s_add_u32 s15, s15, 1572864
  buffer_store_dwordx4 v[8:11], v5, s[60:63], s15 offen sc1
  s_add_u32 s15, s15, 8192
  buffer_store_dwordx4 v[8:11], v5, s[60:63], s15 offen sc1
  v_lshlrev_b32 v4, 10, v1
  v_cmp_gt_u32 vcc, 2, v1
  s_lshl_b32 s15, s14, 7
  s_add_u32 s15, s15, 131072
  v_cndmask_b32 v4, v6, v4, vcc
  buffer_store_dwordx2 v[8:9], v4, s[60:63], s15 offen sc1
  s_lshl_b32 s14, s4, 4
  s_add_u32 s14, s14, s6
  s_lshl_b32 s14, s14, 11
  s_add_u32 s14, s14, 1048576
  buffer_store_dwordx4 v[8:11], v5, s[60:63], s14 offen sc1
  buffer_store_dwordx4 v[8:11], v5, s[60:63], s14 offen offset:1024 sc1
  s_lshl_b32 s15, s10, 2
  v_cmp_gt_u32 vcc, s15, v1
  s_lshl_b32 s14, s9, 2
  s_add_u32 s14, s14, s11
  v_cndmask_b32 v4, v6, v5, vcc
  s_lshl_b32 s14, s14, 7
  s_add_u32 s14, s14, 262144
  buffer_store_dwordx4 v[8:11], v4, s[60:63], s14 offen sc1
  buffer_load_dwordx2 v[12:13], v192, s[56:59], 0 offen sc1
L_e_dma:
  s_and_b32 s12, s3, 1
  s_lshl_b32 s12, s12, 2
  v_add_u32 v4, s12, v2
  v_lshlrev_b32 v4, 1, v4
  v_xor_b32 v4, v4, v3
  v_lshlrev_b32 v4, 4, v4
  v_lshl_add_u32 v4, v2, 13, v4
  s_lshr_b32 s93, s5, 2
  s_mul_i32 s12, s93, 80
  s_lshl_b32 s13, s3, 2
  s_add_u32 s12, s12, s13
  s_lshl_b32 s12, s12, 13
  s_lshl_b32 s13, s7, 8
  s_add_u32 s12, s12, s13
  s_lshl_b32 s13, s3, 10
  s_add_u32 s13, s13, 138240
  s_mov_b64 s[24:25], s[68:69]
  s_mov_b32 s26, 5242880
  s_mov_b32 s27, 0x20000
  s_cmp_ge_u32 s3, 4
  s_cbranch_scc1 L_e_d2
  s_mov_b32 m0, s13
  s_add_u32 s13, s13, 8192
  buffer_load_dwordx4 v4, s[24:27], s12 offen nt lds
  s_add_u32 s12, s12, 262144
L_e_d2:
  s_mov_b32 m0, s13
  s_add_u32 s13, s13, 8192
  buffer_load_dwordx4 v4, s[24:27], s12 offen nt lds
  s_add_u32 s12, s12, 262144
  s_mov_b32 m0, s13
  s_add_u32 s13, s13, 8192
  buffer_load_dwordx4 v4, s[24:27], s12 offen nt lds
  s_add_u32 s12, s12, 262144
  s_cmp_lt_u32 s5, 16
  s_cbranch_scc1 L_e_B
  s_mov_b64 s[20:21], s[66:67]
  s_mov_b32 s22, 16777216
  s_mov_b32 s23, 0x20000
  s_lshl_b32 s12, s4, 11
  s_lshl_b32 s13, s6, 7
  s_add_u32 s12, s12, s13
  s_lshl_b32 s13, s3, 2
  s_add_u32 s12, s12, s13
  s_lshl_b32 s12, s12, 10
  s_mul_i32 s13, s3, 4160
  s_add_u32 s13, s13, 5120
  s_mov_b32 s100, s12
  s_mov_b32 s101, s13
  s_branch L_e_srd
L_e_B:
  s_mov_b64 s[28:29], s[70:71]
  s_mov_b32 s30, 4194304
  s_mov_b32 s31, 0x20000
  v_xor_b32 v4, v3, v2
  v_lshlrev_b32 v4, 4, v4
  v_lshl_add_u32 v4, v2, 13, v4
  s_lshl_b32 s12, s8, 7
  s_lshl_b32 s13, s3, 4
  s_add_u32 s12, s12, s13
  s_lshl_b32 s12, s12, 13
  s_lshl_b32 s13, s7, 8
  s_add_u32 s12, s12, s13
  s_lshl_b32 s13, s3, 12
  s_add_u32 s13, s13, 45056
  s_mov_b32 m0, s13
  s_add_u32 s13, s13, 1024
  buffer_load_dwordx4 v4, s[28:31], s12 offen nt lds
  s_add_u32 s12, s12, 32768
  v_xor_b32 v4, 64, v4
  s_mov_b32 m0, s13
  s_add_u32 s13, s13, 1024
  buffer_load_dwordx4 v4, s[28:31], s12 offen nt lds
  s_add_u32 s12, s12, 32768
  v_xor_b32 v4, 192, v4
  s_mov_b32 m0, s13
  s_add_u32 s13, s13, 1024
  buffer_load_dwordx4 v4, s[28:31], s12 offen nt lds
  s_add_u32 s12, s12, 32768
  v_xor_b32 v4, 64, v4
  s_mov_b32 m0, s13
  s_add_u32 s13, s13, 1024
  buffer_load_dwordx4 v4, s[28:31], s12 offen nt lds
  s_add_u32 s12, s12, 32768
L_e_srd:
  s_mov_b64 s[16:17], s[64:65]
  s_mov_b32 s18, 2560
  s_mov_b32 s19, 0x20000
  s_mov_b64 s[20:21], s[66:67]
  s_mov_b32 s22, 16777216
  s_mov_b32 s23, 0x20000
  s_mov_b64 s[32:33], s[72:73]
  s_mov_b32 s34, 4194304
  s_mov_b32 s35, 0x20000
  s_mov_b64 s[36:37], s[74:75]
  s_mov_b32 s38, 5242880
  s_mov_b32 s39, 0x20000
  s_mov_b64 s[40:41], s[78:79]
  s_mov_b32 s42, 2211840
  s_mov_b32 s43, 0x20000
  s_mov_b64 s[44:45], s[80:81]
  s_mov_b32 s46, 2211840
  s_mov_b32 s47, 0x20000
  s_mov_b64 s[48:49], s[82:83]
  s_mov_b32 s50, 2211840
  s_mov_b32 s51, 0x20000
  s_mov_b64 s[52:53], s[84:85]
  s_mov_b32 s54, 2560
  s_mov_b32 s55, 0x20000
  s_mov_b64 s[56:57], s[86:87]
  s_mov_b32 s58, 256
  s_mov_b32 s59, 0x20000
  s_mov_b64 s[60:61], s[88:89]
  s_mov_b32 s62, 16777216
  s_mov_b32 s63, 0x20000
  s_barrier
  s_cmp_lg_u32 s3, 7
  s_cbranch_scc1 L_s_n7
  s_cmp_lt_u32 s5, 16
  s_cbranch_scc1 L_stA
  s_mov_b32 s92, 0
  s_lshl_b32 s14, s4, 5
  s_add_u32 s14, s14, s5
  s_lshl_b32 s14, s14, 4
  s_add_u32 s14, s14, 0
  s_getreg_b32 s15, hwreg(HW_REG_XCC_ID)
  v_mov_b32 v14, s15
  v_mov_b32 v15, 0
  s_waitcnt vmcnt(2)
  s_branch Le_3
Lp_1:
  buffer_load_dwordx2 v[12:13], v192, s[56:59], 0 offen sc1
  s_waitcnt vmcnt(0)
Le_3:
  v_cmp_ne_u32 vcc, 0, v12
  s_add_u32 s92, s92, 1
  s_cmp_eq_u64 vcc, exec
  s_cbranch_scc1 Ld_2
  s_sleep 4
  s_cmp_lt_u32 s92, 60000
  s_cbranch_scc1 Lp_1
Ld_2:
  ds_write_b64 v192, v[12:13] offset:0
  buffer_store_dwordx4 v[12:15], v7, s[60:63], s14 offen sc1
  s_waitcnt lgkmcnt(0)
  s_mov_b64 exec, 1
  ds_add_u32 v192, v193 offset:64
  s_mov_b64 exec, -1
  s_branch L_stA
L_s_n7:
  s_and_b32 s12, s3, 6
  s_cmp_lg_u32 s12, 4
  s_cbranch_scc1 L_stA
  s_cmp_ge_u32 s5, 16
  s_cbranch_scc1 L_ln_A
  s_waitcnt vmcnt(6)
  s_branch L_ln
  L_ln_A:
  s_waitcnt vmcnt(2)
  L_ln:
  v_lshlrev_b32 v32, 16, v8
  v_and_b32 v33, 0xffff0000, v8
  v_lshlrev_b32 v34, 16, v9
  v_and_b32 v35, 0xffff0000, v9
  v_lshlrev_b32 v36, 16, v10
  v_and_b32 v37, 0xffff0000, v10
  v_lshlrev_b32 v38, 16, v11
  v_and_b32 v39, 0xffff0000, v11
  v_lshlrev_b32 v40, 16, v12
  v_and_b32 v41, 0xffff0000, v12
  v_add_f32 v5, v32, v33
  v_add_f32 v6, v34, v35
  v_add_f32 v5, v5, v36
  v_add_f32 v6, v6, v37
  v_add_f32 v5, v5, v38
  v_add_f32 v6, v6, v39
  v_add_f32 v5, v5, v40
  v_add_f32 v6, v6, v41
  v_add_f32 v5, v5, v6
  s_nop 1
  v_add_f32_dpp v5, v5, v5 row_ror:8 row_mask:0xf bank_mask:0xf
  s_nop 1
  v_add_f32_dpp v5, v5, v5 row_ror:4 row_mask:0xf bank_mask:0xf
  s_nop 1
  v_add_f32_dpp v5, v5, v5 row_ror:2 row_mask:0xf bank_mask:0xf
  s_nop 1
  v_add_f32_dpp v5, v5, v5 row_ror:1 row_mask:0xf bank_mask:0xf
  v_mov_b32 v6, v5
  s_nop 1
  v_permlane16_swap_b32 v5, v6
  v_add_f32 v5, v5, v6
  v_mov_b32 v6, v5
  s_nop 1
  v_permlane32_swap_b32 v5, v6
  v_add_f32 v5, v5, v6
  v_mul_f32 v5, 0x3acccccd, v5
  v_sub_f32 v32, v32, v5
  v_sub_f32 v33, v33, v5
  v_sub_f32 v34, v34, v5
  v_sub_f32 v35, v35, v5
  v_sub_f32 v36, v36, v5
  v_sub_f32 v37, v37, v5
  v_sub_f32 v38, v38, v5
  v_sub_f32 v39, v39, v5
  v_sub_f32 v40, v40, v5
  v_sub_f32 v41, v41, v5
  v_mul_f32 v5, v32, v32
  v_mul_f32 v6, v33, v33
  v_fmac_f32 v5, v34, v34
  v_fmac_f32 v6, v35, v35
  v_fmac_f32 v5, v36, v36
  v_fmac_f32 v6, v37, v37
  v_fmac_f32 v5, v38, v38
  v_fmac_f32 v6, v39, v39
  v_fmac_f32 v5, v40, v40
  v_fmac_f32 v6, v41, v41
  v_add_f32 v5, v5, v6
  s_nop 1
  v_add_f32_dpp v5, v5, v5 row_ror:8 row_mask:0xf bank_mask:0xf
  s_nop 1
  v_add_f32_dpp v5, v5, v5 row_ror:4 row_mask:0xf bank_mask:0xf
  s_nop 1
  v_add_f32_dpp v5, v5, v5 row_ror:2 row_mask:0xf bank_mask:0xf
  s_nop 1
  v_add_f32_dpp v5, v5, v5 row_ror:1 row_mask:0xf bank_mask:0xf
  v_mov_b32 v6, v5
  s_nop 1
  v_permlane16_swap_b32 v5, v6
  v_add_f32 v5, v5, v6
  v_mov_b32 v6, v5
  s_nop 1
  v_permlane32_swap_b32 v5, v6
  v_add_f32 v5, v5, v6
  v_mov_b32 v6, 0x3727c5ac
  s_mov_b32 s13, 0x3acccccd
  v_fma_f32 v5, v5, s13, v6
  v_rsq_f32 v5, v5
  v_add_u32 v4, s15, v100
  v_mul_f32 v32, v32, v5
  v_mul_f32 v33, v33, v5
  v_mul_f32 v34, v34, v5
  v_mul_f32 v35, v35, v5
  v_mul_f32 v36, v36, v5
  v_mul_f32 v37, v37, v5
  v_mul_f32 v38, v38, v5
  v_mul_f32 v39, v39, v5
  v_mul_f32 v40, v40, v5
  v_mul_f32 v41, v41, v5
  v_cvt_pk_bf16_f32 v8, v32, v33
  v_cvt_pk_bf16_f32 v9, v34, v35
  v_cvt_pk_bf16_f32 v10, v36, v37
  v_cvt_pk_bf16_f32 v11, v38, v39
  v_cvt_pk_bf16_f32 v12, v40, v41
  ds_write_b32 v4, v8 offset:2304
  ds_write_b32 v4, v9 offset:2308
  ds_write_b32 v4, v10 offset:2312
  ds_write_b32 v4, v11 offset:2316
  ds_write_b32 v4, v12 offset:2320
L_stA:
  v_lshrrev_b32 v4, 2, v1
  v_and_b32 v5, 7, v4
  v_lshlrev_b32 v5, 1, v5
  v_bfe_u32 v6, v1, 1, 1
  s_lshl_b32 s12, s3, 1
  v_add_u32 v6, s12, v6
  v_xor_b32 v6, v6, v5
  v_lshlrev_b32 v6, 4, v6
  v_lshl_add_u32 v6, v4, 8, v6
  v_and_b32 v5, 1, v1
  v_lshl_add_u32 v6, v5, 3, v6
  v_add_u32 v6, 138240, v6
  v_and_b32 v5, 1, v3
  v_mul_u32_u24 v5, 1280, v5
  v_lshl_add_u32 v5, v2, 3, v5
  s_lshr_b32 s93, s5, 2
  s_mul_i32 s12, s93, 160
  v_add_u32 v5, s12, v5
  v_and_b32 v198, 1, v2
  v_lshlrev_b32 v198, 9, v198
  v_lshrrev_b32 v4, 1, v2
  v_lshl_add_u32 v198, v4, 7, v198
  v_lshl_add_u32 v198, v3, 3, v198
  v_mov_b32 v4, 1073741696
  v_cmp_gt_u32 vcc, 2, v3
  s_lshl_b32 s12, s7, 12
  s_lshl_b32 s13, s93, 4
  v_cndmask_b32 v198, v4, v198, vcc
  s_add_u32 s12, s12, s13
  s_lshr_b32 s13, s3, 1
  s_lshl_b32 s13, s13, 10
  s_add_u32 s12, s12, s13
  s_and_b32 s13, s3, 1
  s_lshl_b32 s13, s13, 8
  s_add_u32 s12, s12, s13
  s_lshl_b32 s99, s12, 1
  s_add_u32 s98, s99, 524288
  s_add_u32 s99, s99, 786432
  v_lshlrev_b32 v199, 1, v198
  v_mov_b32 v8, 0
  v_mov_b32 v9, 0
  v_mov_b32 v10, 0
  v_mov_b32 v11, 0
  s_cmp_lt_u32 s5, 16
  s_cbranch_scc1 L_wB
  s_cmp_eq_u32 s3, 7
  s_cbranch_scc1 L_wA7
  s_waitcnt vmcnt(0)
  L_wA7:
  s_waitcnt vmcnt(1)
  s_branch L_wE
  L_wB:
  s_waitcnt vmcnt(4)
  L_wE:
  s_waitcnt lgkmcnt(0)
  s_barrier
  ds_read_b64 v[14:15], v192 offset:0
  ds_read_b64_tr_b16 v[32:33], v6 offset:0
  ds_read_b64 v[44:45], v5 offset:2304
  ds_read_b64_tr_b16 v[34:35], v6 offset:4096
  ds_read_b64 v[46:47], v5 offset:2336
  ds_read_b64_tr_b16 v[36:37], v6 offset:8192
  ds_read_b64 v[48:49], v5 offset:2368
  ds_read_b64_tr_b16 v[38:39], v6 offset:12288
  ds_read_b64 v[50:51], v5 offset:2400
  ds_read_b64_tr_b16 v[40:41], v6 offset:16384
  ds_read_b64 v[52:53], v5 offset:2432
  s_waitcnt lgkmcnt(8)
  v_mfma_f32_16x16x16_bf16 v[8:11], v[32:33], v[44:45], v[8:11]
  s_waitcnt lgkmcnt(6)
  v_mfma_f32_16x16x16_bf16 v[8:11], v[34:35], v[46:47], v[8:11]
  s_waitcnt lgkmcnt(4)
  v_mfma_f32_16x16x16_bf16 v[8:11], v[36:37], v[48:49], v[8:11]
  s_waitcnt lgkmcnt(2)
  v_mfma_f32_16x16x16_bf16 v[8:11], v[38:39], v[50:51], v[8:11]
  s_waitcnt lgkmcnt(0)
  v_mfma_f32_16x16x16_bf16 v[8:11], v[40:41], v[52:53], v[8:11]
  v_lshlrev_b32 v5, 4, v1
  s_mov_b32 s92, 0
  s_nop 5
  v_cvt_pk_bf16_f32 v12, v8, v9
  v_cvt_pk_bf16_f32 v13, v10, v11
  buffer_store_dwordx4 v[12:15], v199, s[60:63], s98 offen
  v_mov_b32 v196, v12
  v_mov_b32 v197, v13
  s_cmp_ge_u32 s5, 16
  s_cbranch_scc1 L_Awg
  s_lshl_b32 s12, s7, 12
  s_lshl_b32 s13, s3, 9
  s_add_u32 s12, s12, s13
  s_lshl_b32 s95, s12, 1
  s_add_u32 s12, s95, 524288
  s_add_u32 s95, s95, 786432
  v_lshlrev_b32 v102, 3, v1
  v_add_u32 v96, s13, v102
  v_lshlrev_b32 v99, 15, v3
  v_lshl_add_u32 v99, v2, 3, v99
  v_mov_b32 v4, 2147483392
  v_cmp_gt_u32 vcc, 2, v3
  s_lshl_b32 s14, s7, 10
  s_lshl_b32 s15, s8, 8
  v_cndmask_b32 v99, v4, v99, vcc
  s_add_u32 s14, s14, s15
  s_lshl_b32 s15, s3, 5
  s_add_u32 s14, s14, s15
  s_add_u32 s14, s14, 65536
  v_xor_b32 v98, v3, v2
  v_lshlrev_b32 v98, 4, v98
  v_lshl_add_u32 v98, v3, 8, v98
  s_lshl_b32 s15, s3, 12
  s_add_u32 s15, s15, 45056
  v_add_u32 v98, s15, v98
  s_mov_b32 s15, 0
  v_lshl_add_u32 v103, v3, 4, s13
  v_mov_b32 v8, 0
  v_mov_b32 v9, 0
  v_mov_b32 v10, 0
  v_mov_b32 v11, 0
  L_xa_loop:
  s_cmp_eq_u32 s15, 1
  s_cbranch_scc1 L_xa_chk
  buffer_load_dwordx2 v[14:15], v192, s[56:59], 0 offen sc1
  buffer_load_dwordx2 v[36:37], v103, s[60:63], 0 offen offset:256 sc1
  buffer_load_dwordx4 v[32:35], v5, s[60:63], s12 offen sc1
  s_waitcnt vmcnt(0)
  s_cmp_lg_u32 s92, 0
  s_cbranch_scc1 L_xa_n1
  ds_read_b128 v[16:19], v98
  v_xor_b32 v98, 64, v98
  ds_read_b128 v[20:23], v98
  v_xor_b32 v98, 192, v98
  ds_read_b128 v[24:27], v98
  v_xor_b32 v98, 64, v98
  ds_read_b128 v[28:31], v98
  L_xa_n1:
  v_cmp_ne_u32 vcc, 0, v14
  v_cmp_eq_u64 s[100:101], v[36:37], v[14:15]
  v_max_u32 v4, v32, v33
  s_and_b64 vcc, vcc, s[100:101]
  s_cmp_eq_u64 vcc, exec
  s_cbranch_scc0 L_xa_next
  v_cmp_ne_u32 vcc, -1, v4
  v_cmp_eq_u64 s[100:101], v[34:35], v[14:15]
  s_and_b32 vcc_lo, vcc_lo, 0x00ff00ff
  s_and_b32 vcc_hi, vcc_hi, 0x00ff00ff
  s_and_b32 s100, s100, 0xff00ff00
  s_and_b32 s101, s101, 0xff00ff00
  s_or_b64 vcc, s[100:101], vcc
  s_cmp_eq_u64 vcc, exec
  s_cbranch_scc1 L_xa_got
  s_cmp_le_u32 s92, 30
  s_cbranch_scc1 L_xa_next
  buffer_load_dwordx4 v[32:35], v5, s[60:63], s95 offen sc1
  s_waitcnt vmcnt(0)
  v_cmp_eq_u64 vcc, v[34:35], v[14:15]
  s_cmp_eq_u64 vcc, exec
  s_cbranch_scc0 L_xa_next
  L_xa_got:
  ds_write_b64 v96, v[32:33] offset:4864
  s_mov_b32 s15, 1
  s_waitcnt lgkmcnt(0)
  s_mov_b64 exec, 1
  ds_add_u32 v192, v193 offset:76
  s_mov_b64 exec, -1
  L_xa_chk:
  ds_read_b32 v4, v192 offset:76
  s_waitcnt lgkmcnt(0)
  v_cmp_gt_u32 vcc, 8, v4
  s_cbranch_vccz L_xa_done
  L_xa_next:
  s_cmp_lg_u32 s92, 30
  s_cbranch_scc1 L_xa_nf
  s_mov_b32 s93, 0
  L_xa_non:
  buffer_load_dwordx2 v[14:15], v192, s[56:59], 0 offen sc1
  s_waitcnt vmcnt(0)
  v_cmp_ne_u32 vcc, 0, v14
  s_add_u32 s93, s93, 1
  s_cmp_eq_u64 vcc, exec
  s_cbranch_scc1 L_xa_non_d
  s_sleep 4
  s_cmp_lt_u32 s93, 60000
  s_cbranch_scc1 L_xa_non
  L_xa_non_d:
  v_mov_b32 v12, v196
  v_mov_b32 v13, v197
  buffer_store_dwordx4 v[12:15], v199, s[60:63], s99 offen sc1
  L_xa_nf:
  s_and_b32 s93, s92, 3
  s_cmp_lg_u32 s93, 3
  s_cbranch_scc1 L_xa_nr
  buffer_store_dwordx2 v[196:197], v199, s[60:63], s98 offen
  L_xa_nr:
  s_add_u32 s92, s92, 1
  s_cmp_lt_u32 s92, 60000
  s_cbranch_scc1 L_xa_loop
  L_xa_done:
  ds_read_b64 v[32:33], v102 offset:4864
  ds_read_b64 v[34:35], v102 offset:5376
  ds_read_b64 v[36:37], v102 offset:5888
  ds_read_b64 v[38:39], v102 offset:6400
  ds_read_b64 v[40:41], v102 offset:6912
  ds_read_b64 v[42:43], v102 offset:7424
  ds_read_b64 v[44:45], v102 offset:7936
  ds_read_b64 v[46:47], v102 offset:8448
  s_waitcnt lgkmcnt(7)
  v_mfma_f32_16x16x16_bf16 v[8:11], v[16:17], v[32:33], v[8:11]
  s_waitcnt lgkmcnt(6)
  v_mfma_f32_16x16x16_bf16 v[8:11], v[18:19], v[34:35], v[8:11]
  s_waitcnt lgkmcnt(5)
  v_mfma_f32_16x16x16_bf16 v[8:11], v[20:21], v[36:37], v[8:11]
  s_waitcnt lgkmcnt(4)
  v_mfma_f32_16x16x16_bf16 v[8:11], v[22:23], v[38:39], v[8:11]
  s_waitcnt lgkmcnt(3)
  v_mfma_f32_16x16x16_bf16 v[8:11], v[24:25], v[40:41], v[8:11]
  s_waitcnt lgkmcnt(2)
  v_mfma_f32_16x16x16_bf16 v[8:11], v[26:27], v[42:43], v[8:11]
  s_waitcnt lgkmcnt(1)
  v_mfma_f32_16x16x16_bf16 v[8:11], v[28:29], v[44:45], v[8:11]
  s_waitcnt lgkmcnt(0)
  v_mfma_f32_16x16x16_bf16 v[8:11], v[30:31], v[46:47], v[8:11]
  s_nop 7
  v_add_f32_dpp v8, v8, v8 row_ror:8 row_mask:0xf bank_mask:0xf
  v_add_f32_dpp v9, v9, v9 row_ror:8 row_mask:0xf bank_mask:0xf
  v_add_f32_dpp v10, v10, v10 row_ror:8 row_mask:0xf bank_mask:0xf
  v_add_f32_dpp v11, v11, v11 row_ror:8 row_mask:0xf bank_mask:0xf
  v_add_f32_dpp v8, v8, v8 row_ror:4 row_mask:0xf bank_mask:0xf
  v_add_f32_dpp v9, v9, v9 row_ror:4 row_mask:0xf bank_mask:0xf
  v_add_f32_dpp v10, v10, v10 row_ror:4 row_mask:0xf bank_mask:0xf
  v_add_f32_dpp v11, v11, v11 row_ror:4 row_mask:0xf bank_mask:0xf
  v_add_f32_dpp v8, v8, v8 row_ror:2 row_mask:0xf bank_mask:0xf
  v_add_f32_dpp v9, v9, v9 row_ror:2 row_mask:0xf bank_mask:0xf
  v_add_f32_dpp v10, v10, v10 row_ror:2 row_mask:0xf bank_mask:0xf
  v_add_f32_dpp v11, v11, v11 row_ror:2 row_mask:0xf bank_mask:0xf
  v_mul_f32 v8, 0x3e0293ee, v8
  v_mul_f32 v9, 0x3e0293ee, v9
  v_mul_f32 v10, 0x3e0293ee, v10
  v_mul_f32 v11, 0x3e0293ee, v11
  v_cvt_pk_bf16_f32 v104, v8, v9
  v_cvt_pk_bf16_f32 v105, v10, v11
  buffer_store_dwordx2 v[104:105], v99, s[60:63], s14 offen sc1
  v_mov_b32 v12, v196
  v_mov_b32 v13, v197
  v_mov_b32 v108, v14
  v_mov_b32 v195, v14
  v_mov_b32 v109, v15
  s_barrier
  buffer_store_dwordx4 v[12:15], v199, s[60:63], s99 offen sc1
  s_cmp_lg_u32 s3, 7
  s_cbranch_scc1 L_B_pr
  v_mov_b32 v4, 2147483392
  v_cmp_eq_u32 vcc, 0, v1
  s_lshl_b32 s14, s4, 5
  s_add_u32 s14, s14, s5
  v_cndmask_b32 v7, v4, 0, vcc
  s_lshl_b32 s14, s14, 4
  s_add_u32 s14, s14, 0
  s_getreg_b32 s15, hwreg(HW_REG_XCC_ID)
  v_mov_b32 v110, s15
  v_mov_b32 v111, 0
  buffer_store_dwordx4 v[108:111], v7, s[60:63], s14 offen sc1
  L_B_pr:
  s_cmp_lg_u32 s3, 7
  s_cbranch_scc1 L_B_nu
  v_mov_b32 v14, v108
  v_mov_b32 v15, v109
  s_sleep 40
  s_mov_b32 s92, 0
Lp_4:
  buffer_load_dwordx4 v[32:35], v5, s[60:63], 0 offen offset:0 sc1
  buffer_load_dwordx4 v[36:39], v5, s[60:63], 0 offen offset:1024 sc1
  buffer_load_dwordx4 v[40:43], v5, s[60:63], 0 offen offset:2048 sc1
  buffer_load_dwordx4 v[44:47], v5, s[60:63], 0 offen offset:3072 sc1
  s_waitcnt vmcnt(0)
  v_mov_b32 v8, 0
  v_xor_b32 v9, v32, v14
  v_xor_b32 v10, v33, v15
  v_or3_b32 v8, v8, v9, v10
  v_xor_b32 v9, v36, v14
  v_xor_b32 v10, v37, v15
  v_or3_b32 v8, v8, v9, v10
  v_xor_b32 v9, v40, v14
  v_xor_b32 v10, v41, v15
  v_or3_b32 v8, v8, v9, v10
  v_xor_b32 v9, v44, v14
  v_xor_b32 v10, v45, v15
  v_or3_b32 v8, v8, v9, v10
  v_cmp_eq_u32 vcc, 0, v8
  s_add_u32 s92, s92, 1
  s_cmp_eq_u64 vcc, exec
  s_cbranch_scc1 Ld_5
  s_sleep 4
  s_cmp_lt_u32 s92, 60000
  s_cbranch_scc1 Lp_4
Ld_5:
  s_lshr_b32 s14, s4, 1
  s_cmp_eq_u32 s14, 1
  v_mov_b32 v8, v34
  s_cbranch_scc0 Ld_5a
  v_mov_b32 v8, v38
  Ld_5a:
  s_cmp_eq_u32 s14, 2
  s_cbranch_scc0 Ld_5b
  v_mov_b32 v8, v42
  Ld_5b:
  s_cmp_eq_u32 s14, 3
  s_cbranch_scc0 Ld_5c
  v_mov_b32 v8, v46
  Ld_5c:
  s_getreg_b32 s14, hwreg(HW_REG_XCC_ID)
  v_xor_b32 v8, s14, v8
  s_and_b32 s14, s4, 1
  s_lshl_b32 s14, s14, 1
  s_add_u32 s14, s14, 0
  v_cmp_eq_u32 vcc, s14, v2
  s_nop 1
  v_cndmask_b32 v8, 0, v8, vcc
  v_cmp_eq_u32 vcc, 0, v8
  s_cmp_eq_u64 vcc, exec
  s_cselect_b32 s14, 1, 0
  v_mov_b32 v8, s14
  ds_write_b32 v192, v8 offset:8
L_B_nu:
  s_lshl_b32 s12, s4, 4
  s_add_u32 s12, s12, s6
  s_lshl_b32 s12, s12, 7
  s_add_u32 s12, s12, 32768
  s_mov_b32 s92, 0
  s_cmp_lg_u32 s3, 0
  s_cbranch_scc1 L_B_hd
  L_B_hp:
  buffer_load_dwordx2 v[12:13], v192, s[60:63], s12 offen sc1
  s_waitcnt vmcnt(0)
  v_cmp_eq_u64 vcc, v[12:13], v[108:109]
  s_add_u32 s92, s92, 1
  s_cbranch_vccnz L_B_hd
  s_sleep 4
  s_cmp_lt_u32 s92, 200
  s_cbranch_scc1 L_B_hp
  L_B_hd:
  s_barrier
L_B_p2:
  s_lshl_b32 s12, s4, 5
  s_lshl_b32 s13, s6, 1
  s_add_u32 s12, s12, s13
  s_lshr_b32 s13, s3, 2
  s_add_u32 s12, s12, s13
  s_mul_i32 s12, s12, 16640
  s_and_b32 s13, s3, 3
  s_lshl_b32 s13, s13, 12
  s_add_u32 s12, s12, s13
  s_add_u32 s12, s12, 4194304
  v_and_b32 v4, 31, v1
  v_lshlrev_b32 v4, 7, v4
  buffer_load_dword v194, v4, s[60:63], s12 offen nt
  v_lshrrev_b32 v4, 2, v1
  v_lshlrev_b32 v4, 13, v4
  v_and_b32 v6, 3, v1
  v_lshl_add_u32 v4, v6, 4, v4
  s_lshl_b32 s12, s3, 17
  s_lshl_b32 s13, s7, 8
  s_add_u32 s12, s12, s13
  s_lshl_b32 s13, s8, 6
  s_add_u32 s12, s12, s13
  s_lshl_b32 s13, s3, 10
  s_add_u32 s13, s13, 12288
  s_mov_b32 m0, s13
  s_add_u32 s13, s13, 8192
  buffer_load_dwordx4 v4, s[32:35], s12 offen nt lds
  s_add_u32 s12, s12, 1048576
  s_mov_b32 m0, s13
  s_add_u32 s13, s13, 8192
  buffer_load_dwordx4 v4, s[32:35], s12 offen nt lds
  s_add_u32 s12, s12, 1048576
  s_mov_b32 m0, s13
  s_add_u32 s13, s13, 8192
  buffer_load_dwordx4 v4, s[32:35], s12 offen nt lds
  s_add_u32 s12, s12, 1048576
  s_mov_b32 m0, s13
  s_add_u32 s13, s13, 8192
  buffer_load_dwordx4 v4, s[32:35], s12 offen nt lds
  s_add_u32 s12, s12, 1048576
  s_lshl_b32 s12, s7, 7
  s_lshl_b32 s13, s8, 5
  s_add_u32 s12, s12, s13
  s_mul_i32 s12, s12, 1280
  s_lshl_b32 s13, s3, 10
  s_add_u32 s12, s12, s13
  s_add_u32 s13, s13, 45056
  s_mov_b32 m0, s13
  s_add_u32 s13, s13, 8192
  buffer_load_dwordx4 v5, s[36:39], s12 offen nt lds
  s_add_u32 s12, s12, 8192
  s_mov_b32 m0, s13
  s_add_u32 s13, s13, 8192
  buffer_load_dwordx4 v5, s[36:39], s12 offen nt lds
  s_add_u32 s12, s12, 8192
  s_mov_b32 m0, s13
  s_add_u32 s13, s13, 8192
  buffer_load_dwordx4 v5, s[36:39], s12 offen nt lds
  s_add_u32 s12, s12, 8192
  s_mov_b32 m0, s13
  s_add_u32 s13, s13, 8192
  buffer_load_dwordx4 v5, s[36:39], s12 offen nt lds
  s_add_u32 s12, s12, 8192
  s_mov_b32 m0, s13
  s_add_u32 s13, s13, 8192
  buffer_load_dwordx4 v5, s[36:39], s12 offen nt lds
  s_add_u32 s12, s12, 8192
  v_bfe_u32 v4, v1, 2, 2
  v_lshl_add_u32 v4, v2, 3, v4
  v_lshlrev_b32 v16, 6, v4
  v_lshl_add_u32 v16, v6, 3, v16
  s_lshl_b32 s12, s3, 12
  s_add_u32 s12, s12, 12288
  v_add_u32 v16, s12, v16
  v_mul_u32_u24 v17, 1280, v4
  v_lshl_add_u32 v17, v6, 3, v17
  s_mul_i32 s12, s3, 160
  s_add_u32 s12, s12, 45056
  v_add_u32 v17, s12, v17
  v_and_b32 v18, 7, v3
  v_lshlrev_b32 v18, 10, v18
  v_lshl_add_u32 v18, v2, 4, v18
  s_lshl_b32 s12, s7, 13
  s_lshl_b32 s13, s3, 7
  s_add_u32 s12, s12, s13
  s_add_u32 s12, s12, 1572864
  v_and_b32 v4, 1, v2
  v_lshl_add_u32 v19, v4, 2, v6
  v_lshlrev_b32 v19, 7, v19
  s_lshl_b32 s13, s7, 10
  s_add_u32 s13, s13, 131072
  v_lshl_add_u32 v20, v4, 5, v3
  v_lshlrev_b32 v20, 5, v20
  s_lshl_b32 s14, s3, 2
  v_add_u32 v20, s14, v20
  v_lshlrev_b32 v21, 5, v1
  s_lshl_b32 s14, s3, 7
  v_lshl_add_u32 v22, v1, 1, s14
  v_and_b32 v23, 1, v3
  v_lshlrev_b32 v23, 6, v23
  v_lshl_add_u32 v23, v2, 4, v23
  v_add_u32 v23, s14, v23
  v_and_b32 v24, 1, v3
  v_mul_u32_u24 v24, 2560, v24
  v_lshl_add_u32 v24, v2, 4, v24
  v_lshrrev_b32 v7, 1, v3
  v_lshl_add_u32 v24, v7, 6, v24
  v_mov_b32 v4, 1024
  v_cmp_eq_u32 vcc, 0, v7
  v_cmp_eq_u32 s[100:101], 1, v7
  s_nop 0
  v_cndmask_b32 v25, v4, v23, vcc
  v_cndmask_b32 v26, v4, v23, s[100:101]
  v_cmp_eq_u32 vcc, 2, v7
  v_cmp_eq_u32 s[100:101], 3, v7
  s_nop 0
  v_cndmask_b32 v27, v4, v23, vcc
  v_cndmask_b32 v28, v4, v23, s[100:101]
  v_cmp_eq_u32 vcc, 4, v7
  v_lshlrev_b32 v30, 2, v6
  s_nop 0
  v_cndmask_b32 v29, v4, v23, vcc
  ds_write_b32 v30, v192 offset:12032
  v_mov_b32 v4, 2147483392
  v_cmp_gt_u32 vcc, 10, v3
  s_lshl_b32 s93, s4, 4
  s_add_u32 s93, s93, s6
  v_cndmask_b32 v24, v4, v24, vcc
  s_mul_i32 s93, s93, 5120
  s_mul_i32 s94, s3, 320
  s_add_u32 s93, s93, s94
  s_add_u32 s93, s93, 2097152
  v_mov_b32 v8, 0
  v_mov_b32 v9, 0
  v_mov_b32 v10, 0
  v_mov_b32 v11, 0
  v_mov_b32 v12, 0
  v_mov_b32 v13, 0
  v_mov_b32 v14, 0
  v_mov_b32 v15, 0
  v_mov_b32 v64, 0
  v_mov_b32 v65, 0
  v_mov_b32 v66, 0
  v_mov_b32 v67, 0
  s_waitcnt vmcnt(0) lgkmcnt(0)
  s_barrier
  ds_read_b32 v4, v192 offset:8
  s_mul_i32 s14, s4, 81920
  s_lshl_b32 s94, s6, 8
  s_add_u32 s14, s14, s94
  s_add_u32 s14, s14, 2097152
  s_cmp_lg_u32 s3, 0
  s_cbranch_scc1 L_B_np3
  s_cmp_ge_u32 s6, 10
  s_cbranch_scc1 L_B_np3
  v_lshrrev_b32 v5, 1, v1
  v_mul_u32_u24 v5, 2560, v5
  v_and_b32 v6, 1, v1
  v_lshl_add_u32 v5, v6, 7, v5
  buffer_load_dword v6, v5, s[60:63], s14 offen sc1 nt
  L_B_np3:
  s_mul_i32 s95, s3, 10240
  s_add_u32 s14, s14, s95
  v_mul_u32_u24 v30, 2560, v2
  v_lshl_add_u32 v30, v3, 4, v30
  v_and_b32 v7, 1, v2
  v_mul_u32_u24 v31, 2560, v7
  v_lshl_add_u32 v31, v3, 4, v31
  v_lshrrev_b32 v7, 1, v2
  v_lshl_add_u32 v31, v7, 3, v31
  s_mul_i32 s95, s4, 5120
  s_add_u32 s95, s95, s94
  s_add_u32 s95, s95, 196608
  s_lshl_b32 s94, s3, 9
  v_lshl_add_u32 v133, v1, 3, s94
  v_lshlrev_b32 v134, 3, v1
  ds_read_b64_tr_b16 v[96:97], v16 offset:0
  ds_read_b64_tr_b16 v[98:99], v16 offset:256
  ds_read_b64_tr_b16 v[100:101], v16 offset:32
  ds_read_b64_tr_b16 v[102:103], v16 offset:288
  ds_read_b64_tr_b16 v[104:105], v16 offset:2048
  ds_read_b64_tr_b16 v[106:107], v16 offset:2304
  ds_read_b64_tr_b16 v[108:109], v16 offset:2080
  ds_read_b64_tr_b16 v[110:111], v16 offset:2336
  ds_read_b64_tr_b16 v[112:113], v17 offset:0
  ds_read_b64_tr_b16 v[114:115], v17 offset:5120
  ds_read_b64_tr_b16 v[116:117], v17 offset:32
  ds_read_b64_tr_b16 v[118:119], v17 offset:5152
  ds_read_b64_tr_b16 v[120:121], v17 offset:64
  ds_read_b64_tr_b16 v[122:123], v17 offset:5184
  ds_read_b64_tr_b16 v[124:125], v17 offset:96
  ds_read_b64_tr_b16 v[126:127], v17 offset:5216
  ds_read_b64_tr_b16 v[128:129], v17 offset:128
  ds_read_b64_tr_b16 v[130:131], v17 offset:5248
  s_waitcnt lgkmcnt(0)
  v_readfirstlane_b32 s15, v4
  s_lshl_b32 s12, s7, 3
  s_add_u32 s12, s12, s3
  s_lshl_b32 s13, s12, 7
  s_add_u32 s13, s13, 131072
  s_lshl_b32 s12, s12, 10
  s_add_u32 s12, s12, 1572864
  v_lshlrev_b32 v5, 4, v1
  s_mul_i32 s100, s3, 1040
  s_add_u32 s100, s100, 86016
  v_add_u32 v135, s100, v5
  s_lshl_b32 s100, s3, 3
  s_add_u32 s100, s100, 94336
  v_mov_b32 v136, s100
  v_and_b32 v137, 7, v3
  v_mul_u32_u24 v137, 1040, v137
  v_lshl_add_u32 v137, v2, 4, v137
  s_lshl_b32 s100, s3, 7
  s_add_u32 s100, s100, 86016
  v_add_u32 v137, s100, v137
  v_lshrrev_b32 v138, 4, v19
  v_add_u32 v138, 94336, v138
  s_mov_b32 s92, 0
Lp_7:
  buffer_load_dwordx4 v[32:35], v5, s[60:63], s12 offen sc1
  buffer_load_dwordx2 v[36:37], v192, s[60:63], s13 offen sc1
  s_waitcnt vmcnt(0)
  v_max_u32 v4, v32, v33
  v_max3_u32 v4, v4, v34, v35
  v_max3_u32 v4, v4, v36, v37
  v_cmp_ne_u32 vcc, -1, v4
  s_add_u32 s92, s92, 1
  s_cmp_eq_u64 vcc, exec
  s_cbranch_scc1 Ld_8
  s_sleep 2
  s_cmp_lt_u32 s92, 60000
  s_cbranch_scc1 Lp_7
Ld_8:
  ds_write_b128 v135, v[32:35]
  ds_write_b64 v136, v[36:37]
  s_waitcnt lgkmcnt(0)
  s_barrier
  ds_read_b64 v[48:49], v138
  ds_read_b128 v[32:35], v137
  ds_read_b128 v[36:39], v137 offset:64
  s_waitcnt lgkmcnt(0)
  v_mfma_f32_16x16x32_bf16 v[8:11], v[32:35], v[96:99], v[8:11]
  v_mfma_f32_16x16x32_bf16 v[12:15], v[32:35], v[100:103], v[12:15]
  v_max_f32_dpp v4, v48, v48 quad_perm:[1,0,3,2] row_mask:0xf bank_mask:0xf
  v_mfma_f32_16x16x32_bf16 v[8:11], v[36:39], v[104:107], v[8:11]
  v_mfma_f32_16x16x32_bf16 v[12:15], v[36:39], v[108:111], v[12:15]
  v_max_f32_dpp v4, v4, v4 quad_perm:[2,3,0,1] row_mask:0xf bank_mask:0xf
  v_sub_f32 v48, v48, v4
  v_exp_f32 v48, v48
  s_nop 0
  v_mul_f32 v4, v48, v49
  s_nop 1
  v_add_f32_dpp v4, v4, v4 quad_perm:[1,0,3,2] row_mask:0xf bank_mask:0xf
  s_nop 1
  v_add_f32_dpp v4, v4, v4 quad_perm:[2,3,0,1] row_mask:0xf bank_mask:0xf
  v_rcp_f32 v4, v4
  s_nop 0
  v_mul_f32 v48, v48, v4
  s_nop 1
  v_mov_b32_dpp v40, v48 quad_perm:[0,0,0,0] row_mask:0xf bank_mask:0xf
  v_mov_b32_dpp v42, v48 quad_perm:[1,1,1,1] row_mask:0xf bank_mask:0xf
  v_mov_b32_dpp v44, v48 quad_perm:[2,2,2,2] row_mask:0xf bank_mask:0xf
  v_mov_b32_dpp v46, v48 quad_perm:[3,3,3,3] row_mask:0xf bank_mask:0xf
  v_mul_f32 v5, v40, v8
  v_fmac_f32 v5, v42, v9
  v_mul_f32 v6, v40, v12
  v_fmac_f32 v5, v44, v10
  v_fmac_f32 v6, v42, v13
  v_fmac_f32 v5, v46, v11
  v_fmac_f32 v6, v44, v14
  ds_write_b32 v20, v5 offset:8960
  v_fmac_f32 v6, v46, v15
  ds_write_b32 v20, v6 offset:9472
  s_waitcnt lgkmcnt(0)
  s_barrier
  ds_read_b128 v[32:35], v21 offset:8960
  ds_read_b128 v[36:39], v21 offset:8976
  s_waitcnt lgkmcnt(0)
  v_add_f32 v32, v32, v33
  v_add_f32 v34, v34, v35
  v_add_f32 v36, v36, v37
  v_add_f32 v38, v38, v39
  v_add_f32 v32, v32, v34
  v_add_f32 v36, v36, v38
  v_add_f32 v32, v32, v36
  v_cvt_pk_bf16_f32 v32, v32, v32
  ds_write_b16 v22, v32 offset:11008
  s_waitcnt lgkmcnt(0)
  ds_read_b128 v[40:43], v25 offset:11008
  ds_read_b128 v[44:47], v26 offset:11008
  ds_read_b128 v[48:51], v27 offset:11008
  ds_read_b128 v[52:55], v28 offset:11008
  ds_read_b128 v[56:59], v29 offset:11008
  s_waitcnt lgkmcnt(4)
  v_mfma_f32_16x16x32_bf16 v[64:67], v[112:115], v[40:43], v[64:67]
  s_waitcnt lgkmcnt(3)
  v_mfma_f32_16x16x32_bf16 v[64:67], v[116:119], v[44:47], v[64:67]
  s_waitcnt lgkmcnt(2)
  v_mfma_f32_16x16x32_bf16 v[64:67], v[120:123], v[48:51], v[64:67]
  s_waitcnt lgkmcnt(1)
  v_mfma_f32_16x16x32_bf16 v[64:67], v[124:127], v[52:55], v[64:67]
  s_waitcnt lgkmcnt(0)
  v_mfma_f32_16x16x32_bf16 v[64:67], v[128:131], v[56:59], v[64:67]
  s_nop 5
  s_cmp_eq_u32 s15, 1
  s_cbranch_scc1 L_e_fast
  buffer_store_dwordx4 v[64:67], v24, s[60:63], s93 offen sc1
  s_branch L_e_done
  L_e_fast:
  buffer_store_dwordx4 v[64:67], v24, s[60:63], s93 offen
  L_e_done:
  s_cmp_ge_u32 s6, 10
  s_cbranch_scc1 L_fin
  s_sleep 2
  s_mov_b32 s92, 0
Lp_10:
  buffer_load_dwordx4 v[32:35], v30, s[60:63], s14 offen sc1
  s_waitcnt vmcnt(0)
  v_max_u32 v6, v32, v33
  v_max3_u32 v6, v6, v34, v35
  v_cmp_ne_u32 vcc, -1, v6
  s_add_u32 s92, s92, 1
  s_cmp_eq_u64 vcc, exec
  s_cbranch_scc1 Ld_11
  s_sleep 1
  s_cmp_lt_u32 s92, 60000
  s_cbranch_scc1 Lp_10
Ld_11:
  v_permlane32_swap_b32 v32, v34
  v_permlane32_swap_b32 v33, v35
  v_add_f32 v32, v32, v34
  v_add_f32 v33, v33, v35
  ds_write_b64 v133, v[32:33] offset:4864
  s_waitcnt lgkmcnt(0)
  s_barrier
  s_cmp_lg_u32 s3, 0
  s_cbranch_scc1 L_fin
  ds_read_b64 v[32:33], v134 offset:4864
  ds_read_b64 v[34:35], v134 offset:5376
  ds_read_b64 v[36:37], v134 offset:5888
  ds_read_b64 v[38:39], v134 offset:6400
  ds_read_b64 v[40:41], v134 offset:6912
  ds_read_b64 v[42:43], v134 offset:7424
  ds_read_b64 v[44:45], v134 offset:7936
  ds_read_b64 v[46:47], v134 offset:8448
  s_waitcnt lgkmcnt(0)
  v_add_f32 v32, v32, v34
  v_add_f32 v33, v33, v35
  v_add_f32 v36, v36, v38
  v_add_f32 v37, v37, v39
  v_add_f32 v40, v40, v42
  v_add_f32 v41, v41, v43
  v_add_f32 v44, v44, v46
  v_add_f32 v45, v45, v47
  v_add_f32 v32, v32, v36
  v_add_f32 v33, v33, v37
  v_add_f32 v40, v40, v44
  v_add_f32 v41, v41, v45
  v_add_f32 v32, v32, v40
  v_add_f32 v33, v33, v41
  buffer_store_dwordx2 v[32:33], v31, s[60:63], s95 offen sc1
  s_branch L_fin
L_Awg:
  s_lshl_b32 s12, s4, 11
  s_lshl_b32 s13, s6, 7
  s_add_u32 s12, s12, s13
  s_lshl_b32 s13, s3, 4
  s_add_u32 s12, s12, s13
  s_lshl_b32 s12, s12, 10
  s_mul_i32 s13, s3, 16640
  s_add_u32 s13, s13, 5120
  s_lshr_b32 s101, s3, 1
  s_barrier
  buffer_store_dwordx4 v[12:15], v199, s[60:63], s99 offen sc1
  s_cmp_lt_u32 s101, 4
  s_cbranch_scc0 Lt_13
  s_mov_b32 s14, 0
Ltl_14:
  s_mov_b32 m0, s13
  s_add_u32 s13, s13, 1040
  buffer_load_dwordx4 v5, s[20:23], s12 offen nt lds
  s_add_u32 s12, s12, 1024
  s_mov_b32 m0, s13
  s_add_u32 s13, s13, 1040
  buffer_load_dwordx4 v5, s[20:23], s12 offen nt lds
  s_add_u32 s12, s12, 1024
  s_mov_b32 m0, s13
  s_add_u32 s13, s13, 1040
  buffer_load_dwordx4 v5, s[20:23], s12 offen nt lds
  s_add_u32 s12, s12, 1024
  s_mov_b32 m0, s13
  s_add_u32 s13, s13, 1040
  buffer_load_dwordx4 v5, s[20:23], s12 offen nt lds
  s_add_u32 s12, s12, 1024
  s_add_u32 s14, s14, 1
  s_cmp_lt_u32 s14, 4
  s_cbranch_scc1 Ltl_14
Lt_13:
  v_and_b32 v16, 7, v3
  v_lshlrev_b32 v16, 1, v16
  v_lshrrev_b32 v4, 3, v3
  v_add_u32 v16, v16, v4
  s_lshl_b32 s14, s3, 4
  v_add_u32 v16, s14, v16
  v_mul_u32_u24 v16, 1040, v16
  v_lshl_add_u32 v16, v2, 8, v16
  v_add_u32 v16, 5120, v16
  v_and_b32 v17, 1, v2
  v_lshlrev_b32 v17, 3, v17
  v_bfe_u32 v4, v1, 2, 2
  v_lshl_add_u32 v17, v4, 1, v17
  v_lshrrev_b32 v4, 1, v2
  v_add_u32 v17, v17, v4
  v_mul_u32_u24 v17, 1040, v17
  v_and_b32 v4, 3, v1
  v_lshl_add_u32 v17, v4, 3, v17
  s_lshl_b32 s14, s3, 7
  s_add_u32 s14, s14, 5120
  v_add_u32 v17, s14, v17
  v_mul_u32_u24 v18, 1040, v3
  v_lshl_add_u32 v18, v2, 8, v18
  v_lshlrev_b32 v19, 5, v3
  s_lshl_b32 s14, s3, 2
  v_add_u32 v20, s14, v19
  s_lshr_b32 s14, s3, 1
  s_lshl_b32 s14, s14, 10
  s_and_b32 s15, s3, 1
  s_lshl_b32 s15, s15, 3
  s_add_u32 s14, s14, s15
  v_add_u32 v21, s14, v5
  s_mul_i32 s14, s3, 4160
  v_add_u32 v22, s14, v5
  v_lshrrev_b32 v23, 1, v2
  v_and_b32 v4, 7, v3
  v_xor_b32 v23, v23, v4
  v_lshlrev_b32 v23, 4, v23
  v_lshl_add_u32 v23, v3, 7, v23
  v_and_b32 v4, 1, v2
  v_lshl_add_u32 v23, v4, 3, v23
  s_lshl_b32 s14, s3, 12
  s_add_u32 s14, s14, 71680
  v_add_u32 v23, s14, v23
  v_xor_b32 v24, 32, v23
  v_xor_b32 v25, 64, v23
  v_xor_b32 v26, 96, v23
  v_lshrrev_b32 v30, 3, v1
  v_and_b32 v31, 7, v1
  v_xor_b32 v27, v30, v31
  v_lshlrev_b32 v27, 4, v27
  v_lshl_add_u32 v27, v30, 7, v27
  v_add_u32 v27, s14, v27
  s_mov_b32 s14, 16640
  v_mul_lo_u32 v28, v30, s14
  v_lshl_add_u32 v28, v31, 4, v28
  v_lshlrev_b32 v29, 7, v1
  v_mov_b32 v4, 2147483392
  v_cmp_gt_u32 vcc, 32, v1
  s_lshr_b32 s94, s4, 2
  s_lshl_b32 s94, s94, 15
  v_cndmask_b32 v29, v4, v29, vcc
  s_lshl_b32 s14, s3, 12
  s_add_u32 s94, s94, s14
  s_add_u32 s94, s94, 65536
  s_cmp_lg_u32 s101, 0
  s_cbranch_scc1 L_A_na0
  s_waitcnt vmcnt(0)
  ds_read_b128 v[32:35], v16 offset:0
  ds_read_b128 v[36:39], v16 offset:16
  ds_read_b128 v[40:43], v16 offset:32
  ds_read_b128 v[44:47], v16 offset:48
  ds_read_b128 v[48:51], v16 offset:64
  ds_read_b128 v[52:55], v16 offset:80
  ds_read_b128 v[56:59], v16 offset:96
  ds_read_b128 v[60:63], v16 offset:112
  ds_read_b128 v[64:67], v16 offset:128
  ds_read_b128 v[68:71], v16 offset:144
  ds_read_b128 v[72:75], v16 offset:160
  ds_read_b128 v[76:79], v16 offset:176
  ds_read_b128 v[80:83], v16 offset:192
  ds_read_b128 v[84:87], v16 offset:208
  ds_read_b128 v[88:91], v16 offset:224
  ds_read_b128 v[92:95], v16 offset:240
L_A_na0:
  s_barrier
  ds_read_b64_tr_b16 v[128:129], v17 offset:0
  ds_read_b64_tr_b16 v[130:131], v17 offset:16640
  ds_read_b64_tr_b16 v[144:145], v17 offset:32
  ds_read_b64_tr_b16 v[146:147], v17 offset:16672
  ds_read_b64_tr_b16 v[160:161], v17 offset:64
  ds_read_b64_tr_b16 v[162:163], v17 offset:16704
  ds_read_b64_tr_b16 v[176:177], v17 offset:96
  ds_read_b64_tr_b16 v[178:179], v17 offset:16736
  v_add_u32 v17, 33280, v17
  s_cmp_lg_u32 s101, 1
  s_cbranch_scc1 L_A_na1
  s_waitcnt vmcnt(0)
  ds_read_b128 v[32:35], v16 offset:0
  ds_read_b128 v[36:39], v16 offset:16
  ds_read_b128 v[40:43], v16 offset:32
  ds_read_b128 v[44:47], v16 offset:48
  ds_read_b128 v[48:51], v16 offset:64
  ds_read_b128 v[52:55], v16 offset:80
  ds_read_b128 v[56:59], v16 offset:96
  ds_read_b128 v[60:63], v16 offset:112
  ds_read_b128 v[64:67], v16 offset:128
  ds_read_b128 v[68:71], v16 offset:144
  ds_read_b128 v[72:75], v16 offset:160
  ds_read_b128 v[76:79], v16 offset:176
  ds_read_b128 v[80:83], v16 offset:192
  ds_read_b128 v[84:87], v16 offset:208
  ds_read_b128 v[88:91], v16 offset:224
  ds_read_b128 v[92:95], v16 offset:240
L_A_na1:
  s_waitcnt lgkmcnt(0)
  s_barrier
  s_cmp_lg_u32 s3, 0
  s_cbranch_scc1 L_A_nf
  buffer_load_dwordx4 v[112:115], v5, s[60:63], 0 offen offset:0 sc1
  buffer_load_dwordx4 v[116:119], v5, s[60:63], 0 offen offset:1024 sc1
  buffer_load_dwordx4 v[120:123], v5, s[60:63], 0 offen offset:2048 sc1
  buffer_load_dwordx4 v[124:127], v5, s[60:63], 0 offen offset:3072 sc1
L_A_nf:
  s_lshl_b32 s14, s4, 4
  s_add_u32 s14, s14, s6
  s_lshl_b32 s14, s14, 7
  s_add_u32 s14, s14, 32768
  v_mov_b32 v4, 2147483392
  v_cmp_eq_u32 vcc, 0, v0
  s_nop 1
  v_cndmask_b32 v4, v4, 0, vcc
  buffer_store_dwordx2 v[14:15], v4, s[60:63], s14 offen sc1
  ds_read_b64_tr_b16 v[132:133], v17 offset:0
  ds_read_b64_tr_b16 v[134:135], v17 offset:16640
  ds_read_b64_tr_b16 v[148:149], v17 offset:32
  ds_read_b64_tr_b16 v[150:151], v17 offset:16672
  ds_read_b64_tr_b16 v[164:165], v17 offset:64
  ds_read_b64_tr_b16 v[166:167], v17 offset:16704
  ds_read_b64_tr_b16 v[180:181], v17 offset:96
  ds_read_b64_tr_b16 v[182:183], v17 offset:16736
  v_add_u32 v17, 33280, v17
  s_cmp_lg_u32 s101, 2
  s_cbranch_scc1 L_A_na2
  s_waitcnt vmcnt(0)
  ds_read_b128 v[32:35], v16 offset:0
  ds_read_b128 v[36:39], v16 offset:16
  ds_read_b128 v[40:43], v16 offset:32
  ds_read_b128 v[44:47], v16 offset:48
  ds_read_b128 v[48:51], v16 offset:64
  ds_read_b128 v[52:55], v16 offset:80
  ds_read_b128 v[56:59], v16 offset:96
  ds_read_b128 v[60:63], v16 offset:112
  ds_read_b128 v[64:67], v16 offset:128
  ds_read_b128 v[68:71], v16 offset:144
  ds_read_b128 v[72:75], v16 offset:160
  ds_read_b128 v[76:79], v16 offset:176
  ds_read_b128 v[80:83], v16 offset:192
  ds_read_b128 v[84:87], v16 offset:208
  ds_read_b128 v[88:91], v16 offset:224
  ds_read_b128 v[92:95], v16 offset:240
L_A_na2:
  s_cmp_lg_u32 s3, 0
  s_cbranch_scc1 L_A_w2
  s_mov_b32 s92, 0
  s_waitcnt vmcnt(0)
  s_branch Le_17
Lp_15:
  buffer_load_dwordx4 v[112:115], v5, s[60:63], 0 offen offset:0 sc1
  buffer_load_dwordx4 v[116:119], v5, s[60:63], 0 offen offset:1024 sc1
  buffer_load_dwordx4 v[120:123], v5, s[60:63], 0 offen offset:2048 sc1
  buffer_load_dwordx4 v[124:127], v5, s[60:63], 0 offen offset:3072 sc1
  s_waitcnt vmcnt(0)
Le_17:
  v_mov_b32 v8, 0
  v_xor_b32 v9, v112, v14
  v_xor_b32 v10, v113, v15
  v_or3_b32 v8, v8, v9, v10
  v_xor_b32 v9, v116, v14
  v_xor_b32 v10, v117, v15
  v_or3_b32 v8, v8, v9, v10
  v_xor_b32 v9, v120, v14
  v_xor_b32 v10, v121, v15
  v_or3_b32 v8, v8, v9, v10
  v_xor_b32 v9, v124, v14
  v_xor_b32 v10, v125, v15
  v_or3_b32 v8, v8, v9, v10
  v_cmp_eq_u32 vcc, 0, v8
  s_add_u32 s92, s92, 1
  s_or_b32 vcc_lo, vcc_lo, 0xffff
  s_or_b32 vcc_hi, vcc_hi, 0xffff
  s_cmp_eq_u64 vcc, exec
  s_cbranch_scc1 Ld_16
  s_sleep 4
  s_cmp_lt_u32 s92, 60000
  s_cbranch_scc1 Lp_15
Ld_16:
  s_lshr_b32 s14, s4, 1
  s_cmp_eq_u32 s14, 1
  v_mov_b32 v8, v114
  s_cbranch_scc0 Ld_16a
  v_mov_b32 v8, v118
  Ld_16a:
  s_cmp_eq_u32 s14, 2
  s_cbranch_scc0 Ld_16b
  v_mov_b32 v8, v122
  Ld_16b:
  s_cmp_eq_u32 s14, 3
  s_cbranch_scc0 Ld_16c
  v_mov_b32 v8, v126
  Ld_16c:
  s_getreg_b32 s14, hwreg(HW_REG_XCC_ID)
  v_xor_b32 v8, s14, v8
  s_and_b32 s14, s4, 1
  s_lshl_b32 s14, s14, 1
  s_add_u32 s14, s14, 1
  v_cmp_eq_u32 vcc, s14, v2
  s_nop 1
  v_cndmask_b32 v8, 0, v8, vcc
  v_cmp_eq_u32 vcc, 0, v8
  s_cmp_eq_u64 vcc, exec
  s_cselect_b32 s14, 1, 0
  v_mov_b32 v8, s14
  ds_write_b32 v192, v8 offset:8
L_A_w2:
  s_waitcnt lgkmcnt(0)
  s_barrier
  buffer_load_dwordx4 v[96:99], v5, s[60:63], s94 offen offset:0 sc1
  buffer_load_dwordx4 v[100:103], v5, s[60:63], s94 offen offset:1024 sc1
  buffer_load_dwordx4 v[104:107], v5, s[60:63], s94 offen offset:2048 sc1
  buffer_load_dwordx4 v[108:111], v5, s[60:63], s94 offen offset:3072 sc1
  ds_read_b64_tr_b16 v[136:137], v17 offset:0
  ds_read_b64_tr_b16 v[138:139], v17 offset:16640
  ds_read_b64_tr_b16 v[152:153], v17 offset:32
  ds_read_b64_tr_b16 v[154:155], v17 offset:16672
  ds_read_b64_tr_b16 v[168:169], v17 offset:64
  ds_read_b64_tr_b16 v[170:171], v17 offset:16704
  ds_read_b64_tr_b16 v[184:185], v17 offset:96
  ds_read_b64_tr_b16 v[186:187], v17 offset:16736
  v_add_u32 v17, 33280, v17
  s_cmp_lg_u32 s101, 3
  s_cbranch_scc1 L_A_na3
  s_waitcnt vmcnt(4)
  ds_read_b128 v[32:35], v16 offset:0
  ds_read_b128 v[36:39], v16 offset:16
  ds_read_b128 v[40:43], v16 offset:32
  ds_read_b128 v[44:47], v16 offset:48
  ds_read_b128 v[48:51], v16 offset:64
  ds_read_b128 v[52:55], v16 offset:80
  ds_read_b128 v[56:59], v16 offset:96
  ds_read_b128 v[60:63], v16 offset:112
  ds_read_b128 v[64:67], v16 offset:128
  ds_read_b128 v[68:71], v16 offset:144
  ds_read_b128 v[72:75], v16 offset:160
  ds_read_b128 v[76:79], v16 offset:176
  ds_read_b128 v[80:83], v16 offset:192
  ds_read_b128 v[84:87], v16 offset:208
  ds_read_b128 v[88:91], v16 offset:224
  ds_read_b128 v[92:95], v16 offset:240
L_A_na3:
  s_barrier
  ds_read_b64_tr_b16 v[140:141], v17 offset:0
  ds_read_b64_tr_b16 v[142:143], v17 offset:16640
  ds_read_b64_tr_b16 v[156:157], v17 offset:32
  ds_read_b64_tr_b16 v[158:159], v17 offset:16672
  ds_read_b64_tr_b16 v[172:173], v17 offset:64
  ds_read_b64_tr_b16 v[174:175], v17 offset:16704
  ds_read_b64_tr_b16 v[188:189], v17 offset:96
  ds_read_b64_tr_b16 v[190:191], v17 offset:16736
  ds_read_b32 v6, v192 offset:8
  s_mov_b32 s92, 0
  s_branch Le_20
Lp_18:
  buffer_load_dwordx4 v[96:99], v5, s[60:63], s94 offen offset:0 sc1
  buffer_load_dwordx4 v[100:103], v5, s[60:63], s94 offen offset:1024 sc1
  buffer_load_dwordx4 v[104:107], v5, s[60:63], s94 offen offset:2048 sc1
  buffer_load_dwordx4 v[108:111], v5, s[60:63], s94 offen offset:3072 sc1
Le_20:
  s_waitcnt vmcnt(0)
  v_max_u32 v4, v96, v97
  v_max3_u32 v4, v4, v98, v99
  v_max3_u32 v4, v4, v100, v101
  v_max3_u32 v4, v4, v102, v103
  v_max3_u32 v4, v4, v104, v105
  v_max3_u32 v4, v4, v106, v107
  v_max3_u32 v4, v4, v108, v109
  v_max3_u32 v4, v4, v110, v111
  v_cmp_ne_u32 vcc, -1, v4
  s_add_u32 s92, s92, 1
  s_cmp_eq_u64 vcc, exec
  s_cbranch_scc1 Ld_19
  s_sleep 4
  s_cmp_lt_u32 s92, 60000
  s_cbranch_scc1 Lp_18
Ld_19:
  ds_write_b128 v22, v[96:99] offset:5120
  ds_write_b128 v22, v[100:103] offset:6160
  ds_write_b128 v22, v[104:107] offset:7200
  ds_write_b128 v22, v[108:111] offset:8240
  s_lshl_b32 s93, s4, 4
  s_add_u32 s93, s93, s6
  s_lshl_b32 s93, s93, 8
  s_add_u32 s93, s93, 327680
  s_cmp_lg_u32 s3, 3
  s_cbranch_scc1 L_A_npm
  v_lshlrev_b32 v4, 2, v1
  buffer_load_dword v194, v4, s[60:63], s93 offen sc1 nt
  L_A_npm:
  v_mov_b32 v8, 0
  v_mov_b32 v9, 0
  v_mov_b32 v10, 0
  v_mov_b32 v11, 0
  v_mov_b32 v12, 0
  v_mov_b32 v13, 0
  v_mov_b32 v14, 0
  v_mov_b32 v15, 0
  s_waitcnt lgkmcnt(0)
  s_barrier
  v_readfirstlane_b32 s15, v6
  s_cmp_eq_u32 s10, 1
  s_cbranch_scc1 L_A_nw2
  v_lshrrev_b32 v4, 2, v1
  v_mul_u32_u24 v4, 1280, v4
  v_and_b32 v6, 3, v1
  v_lshl_add_u32 v4, v6, 4, v4
  s_mul_i32 s12, s3, 20480
  s_lshl_b32 s13, s9, 6
  s_add_u32 s12, s12, s13
  s_add_u32 s12, s12, 1802240
  s_lshl_b32 s13, s3, 10
  s_add_u32 s13, s13, 138240
  s_mov_b32 m0, s13
  s_add_u32 s13, s13, 8192
  buffer_load_dwordx4 v4, s[48:51], s12 offen nt lds
  s_add_u32 s12, s12, 163840
  s_mov_b32 m0, s13
  s_add_u32 s13, s13, 8192
  buffer_load_dwordx4 v4, s[48:51], s12 offen nt lds
  s_add_u32 s12, s12, 163840
  s_cmp_ge_u32 s3, 4
  s_cbranch_scc1 L_w2b
  s_mov_b32 m0, s13
  s_add_u32 s13, s13, 8192
  buffer_load_dwordx4 v4, s[48:51], s12 offen nt lds
  s_add_u32 s12, s12, 163840
L_w2b:
L_A_nw2:
  ds_read_b128 v[96:99], v18 offset:5120
  ds_read_b128 v[100:103], v18 offset:21760
  ds_read_b128 v[104:107], v18 offset:5136
  ds_read_b128 v[108:111], v18 offset:21776
  ds_read_b128 v[112:115], v18 offset:5152
  ds_read_b128 v[116:119], v18 offset:21792
  ds_read_b128 v[120:123], v18 offset:5168
  ds_read_b128 v[124:127], v18 offset:21808
  s_waitcnt lgkmcnt(7)
  v_mfma_f32_16x16x32_bf16 v[8:11], v[32:35], v[96:99], v[8:11]
  ds_read_b128 v[96:99], v18 offset:5184
  s_waitcnt lgkmcnt(7)
  v_mfma_f32_16x16x32_bf16 v[12:15], v[32:35], v[100:103], v[12:15]
  ds_read_b128 v[100:103], v18 offset:21824
  s_waitcnt lgkmcnt(7)
  v_mfma_f32_16x16x32_bf16 v[8:11], v[36:39], v[104:107], v[8:11]
  ds_read_b128 v[104:107], v18 offset:5200
  s_waitcnt lgkmcnt(7)
  v_mfma_f32_16x16x32_bf16 v[12:15], v[36:39], v[108:111], v[12:15]
  ds_read_b128 v[108:111], v18 offset:21840
  s_waitcnt lgkmcnt(7)
  v_mfma_f32_16x16x32_bf16 v[8:11], v[40:43], v[112:115], v[8:11]
  ds_read_b128 v[112:115], v18 offset:5216
  s_waitcnt lgkmcnt(7)
  v_mfma_f32_16x16x32_bf16 v[12:15], v[40:43], v[116:119], v[12:15]
  ds_read_b128 v[116:119], v18 offset:21856
  s_waitcnt lgkmcnt(7)
  v_mfma_f32_16x16x32_bf16 v[8:11], v[44:47], v[120:123], v[8:11]
  ds_read_b128 v[120:123], v18 offset:5232
  s_waitcnt lgkmcnt(7)
  v_mfma_f32_16x16x32_bf16 v[12:15], v[44:47], v[124:127], v[12:15]
  ds_read_b128 v[124:127], v18 offset:21872
  s_waitcnt lgkmcnt(7)
  v_mfma_f32_16x16x32_bf16 v[8:11], v[48:51], v[96:99], v[8:11]
  ds_read_b128 v[96:99], v18 offset:5248
  s_waitcnt lgkmcnt(7)
  v_mfma_f32_16x16x32_bf16 v[12:15], v[48:51], v[100:103], v[12:15]
  ds_read_b128 v[100:103], v18 offset:21888
  s_waitcnt lgkmcnt(7)
  v_mfma_f32_16x16x32_bf16 v[8:11], v[52:55], v[104:107], v[8:11]
  ds_read_b128 v[104:107], v18 offset:5264
  s_waitcnt lgkmcnt(7)
  v_mfma_f32_16x16x32_bf16 v[12:15], v[52:55], v[108:111], v[12:15]
  ds_read_b128 v[108:111], v18 offset:21904
  s_waitcnt lgkmcnt(7)
  v_mfma_f32_16x16x32_bf16 v[8:11], v[56:59], v[112:115], v[8:11]
  ds_read_b128 v[112:115], v18 offset:5280
  s_waitcnt lgkmcnt(7)
  v_mfma_f32_16x16x32_bf16 v[12:15], v[56:59], v[116:119], v[12:15]
  ds_read_b128 v[116:119], v18 offset:21920
  s_waitcnt lgkmcnt(7)
  v_mfma_f32_16x16x32_bf16 v[8:11], v[60:63], v[120:123], v[8:11]
  ds_read_b128 v[120:123], v18 offset:5296
  s_waitcnt lgkmcnt(7)
  v_mfma_f32_16x16x32_bf16 v[12:15], v[60:63], v[124:127], v[12:15]
  ds_read_b128 v[124:127], v18 offset:21936
  s_waitcnt lgkmcnt(7)
  v_mfma_f32_16x16x32_bf16 v[8:11], v[64:67], v[96:99], v[8:11]
  ds_read_b128 v[96:99], v18 offset:5312
  s_waitcnt lgkmcnt(7)
  v_mfma_f32_16x16x32_bf16 v[12:15], v[64:67], v[100:103], v[12:15]
  ds_read_b128 v[100:103], v18 offset:21952
  s_waitcnt lgkmcnt(7)
  v_mfma_f32_16x16x32_bf16 v[8:11], v[68:71], v[104:107], v[8:11]
  ds_read_b128 v[104:107], v18 offset:5328
  s_waitcnt lgkmcnt(7)
  v_mfma_f32_16x16x32_bf16 v[12:15], v[68:71], v[108:111], v[12:15]
  ds_read_b128 v[108:111], v18 offset:21968
  s_waitcnt lgkmcnt(7)
  v_mfma_f32_16x16x32_bf16 v[8:11], v[72:75], v[112:115], v[8:11]
  ds_read_b128 v[112:115], v18 offset:5344
  s_waitcnt lgkmcnt(7)
  v_mfma_f32_16x16x32_bf16 v[12:15], v[72:75], v[116:119], v[12:15]
  ds_read_b128 v[116:119], v18 offset:21984
  s_waitcnt lgkmcnt(7)
  v_mfma_f32_16x16x32_bf16 v[8:11], v[76:79], v[120:123], v[8:11]
  ds_read_b128 v[120:123], v18 offset:5360
  s_waitcnt lgkmcnt(7)
  v_mfma_f32_16x16x32_bf16 v[12:15], v[76:79], v[124:127], v[12:15]
  ds_read_b128 v[124:127], v18 offset:22000
  s_waitcnt lgkmcnt(7)
  v_mfma_f32_16x16x32_bf16 v[8:11], v[80:83], v[96:99], v[8:11]
  s_waitcnt lgkmcnt(6)
  v_mfma_f32_16x16x32_bf16 v[12:15], v[80:83], v[100:103], v[12:15]
  s_waitcnt lgkmcnt(5)
  v_mfma_f32_16x16x32_bf16 v[8:11], v[84:87], v[104:107], v[8:11]
  s_waitcnt lgkmcnt(4)
  v_mfma_f32_16x16x32_bf16 v[12:15], v[84:87], v[108:111], v[12:15]
  s_waitcnt lgkmcnt(3)
  v_mfma_f32_16x16x32_bf16 v[8:11], v[88:91], v[112:115], v[8:11]
  s_waitcnt lgkmcnt(2)
  v_mfma_f32_16x16x32_bf16 v[12:15], v[88:91], v[116:119], v[12:15]
  s_waitcnt lgkmcnt(1)
  v_mfma_f32_16x16x32_bf16 v[8:11], v[92:95], v[120:123], v[8:11]
  s_waitcnt lgkmcnt(0)
  v_mfma_f32_16x16x32_bf16 v[12:15], v[92:95], v[124:127], v[12:15]
  v_mov_b32 v32, 0
  v_mov_b32 v33, 0
  v_mov_b32 v34, 0
  v_mov_b32 v35, 0
  v_mov_b32 v36, 0
  v_mov_b32 v37, 0
  v_mov_b32 v38, 0
  v_mov_b32 v39, 0
  v_max_f32 v4, v8, v9
  v_max_f32 v6, v12, v13
  v_max3_f32 v4, v4, v10, v11
  v_max3_f32 v6, v6, v14, v15
  s_nop 1
  v_permlane16_swap_b32 v4, v6
  v_max_f32 v4, v4, v6
  v_mov_b32 v6, v4
  s_nop 1
  v_permlane32_swap_b32 v4, v6
  v_max_f32 v4, v4, v6
  v_and_b32 v6, 1, v2
  v_lshl_add_u32 v7, v6, 9, v20
  ds_write_b32 v7, v4 offset:256
  v_mov_b32 v40, 0
  v_mov_b32 v41, 0
  v_mov_b32 v42, 0
  v_mov_b32 v43, 0
  v_mov_b32 v44, 0
  v_mov_b32 v45, 0
  v_mov_b32 v46, 0
  v_mov_b32 v47, 0
  v_mov_b32 v48, 0
  v_mov_b32 v49, 0
  v_mov_b32 v50, 0
  v_mov_b32 v51, 0
  v_mov_b32 v52, 0
  v_mov_b32 v53, 0
  v_mov_b32 v54, 0
  v_mov_b32 v55, 0
  v_mov_b32 v56, 0
  v_mov_b32 v57, 0
  v_mov_b32 v58, 0
  v_mov_b32 v59, 0
  v_mov_b32 v60, 0
  v_mov_b32 v61, 0
  v_mov_b32 v62, 0
  v_mov_b32 v63, 0
  s_waitcnt lgkmcnt(0)
  s_barrier
  ds_read_b128 v[96:99], v19 offset:256
  ds_read_b128 v[100:103], v19 offset:272
  ds_read_b128 v[104:107], v19 offset:768
  ds_read_b128 v[108:111], v19 offset:784
  s_waitcnt lgkmcnt(2)
  v_max3_f32 v4, v96, v97, v98
  v_max3_f32 v4, v4, v99, v100
  v_max3_f32 v4, v4, v101, v102
  v_max_f32 v4, v4, v103
  s_waitcnt lgkmcnt(0)
  v_max3_f32 v6, v104, v105, v106
  v_max3_f32 v6, v6, v107, v108
  v_max3_f32 v6, v6, v109, v110
  v_max_f32 v6, v6, v111
  v_sub_f32 v8, v8, v4
  v_sub_f32 v12, v12, v6
  v_sub_f32 v9, v9, v4
  v_sub_f32 v13, v13, v6
  v_sub_f32 v10, v10, v4
  v_sub_f32 v14, v14, v6
  v_sub_f32 v11, v11, v4
  v_sub_f32 v15, v15, v6
  v_exp_f32 v8, v8
  v_exp_f32 v9, v9
  v_exp_f32 v10, v10
  v_exp_f32 v11, v11
  v_exp_f32 v12, v12
  v_exp_f32 v13, v13
  v_exp_f32 v14, v14
  v_exp_f32 v15, v15
  s_nop 0
  v_cvt_pk_bf16_f32 v96, v8, v9
  v_cvt_pk_bf16_f32 v97, v10, v11
  v_cvt_pk_bf16_f32 v98, v12, v13
  v_cvt_pk_bf16_f32 v99, v14, v15
  ds_write_b64 v21, v[96:97] offset:38400
  ds_write_b64 v21, v[98:99] offset:42496
  v_add_f32 v4, v8, v9
  v_add_f32 v6, v12, v13
  v_add_f32 v8, v10, v11
  v_add_f32 v9, v14, v15
  v_add_f32 v4, v4, v8
  v_add_f32 v6, v6, v9
  s_nop 1
  v_permlane16_swap_b32 v4, v6
  v_add_f32 v4, v4, v6
  v_mov_b32 v6, v4
  s_nop 1
  v_permlane32_swap_b32 v4, v6
  v_add_f32 v4, v4, v6
  ds_write_b32 v7, v4 offset:1280
  s_mul_i32 s12, s4, 532480
  s_lshl_b32 s13, s6, 10
  s_add_u32 s12, s12, s13
  s_lshl_b32 s13, s3, 7
  s_add_u32 s12, s12, s13
  s_add_u32 s12, s12, 4194304
  s_lshl_b32 s13, s4, 12
  s_lshl_b32 s14, s6, 3
  s_add_u32 s13, s13, s14
  s_add_u32 s13, s13, 327680
  v_and_b32 v6, 31, v1
  v_lshlrev_b32 v6, 5, v6
  s_waitcnt lgkmcnt(0)
  s_barrier
  ds_read_b128 v[64:67], v5 offset:38400
  ds_read_b128 v[68:71], v5 offset:39424
  ds_read_b128 v[72:75], v5 offset:40448
  ds_read_b128 v[76:79], v5 offset:41472
  ds_read_b128 v[80:83], v5 offset:42496
  ds_read_b128 v[84:87], v5 offset:43520
  ds_read_b128 v[88:91], v5 offset:44544
  ds_read_b128 v[92:95], v5 offset:45568
  s_cmp_eq_u32 s15, 1
  s_cbranch_scc1 L_pv_fast
  s_waitcnt lgkmcnt(4)
  v_mfma_f32_16x16x32_bf16 v[32:35], v[128:131], v[64:67], v[32:35]
  v_mfma_f32_16x16x32_bf16 v[32:35], v[132:135], v[68:71], v[32:35]
  v_mfma_f32_16x16x32_bf16 v[32:35], v[136:139], v[72:75], v[32:35]
  v_mfma_f32_16x16x32_bf16 v[32:35], v[140:143], v[76:79], v[32:35]
  v_mfma_f32_16x16x32_bf16 v[40:43], v[144:147], v[64:67], v[40:43]
  v_mfma_f32_16x16x32_bf16 v[40:43], v[148:151], v[68:71], v[40:43]
  v_mfma_f32_16x16x32_bf16 v[40:43], v[152:155], v[72:75], v[40:43]
  v_mfma_f32_16x16x32_bf16 v[40:43], v[156:159], v[76:79], v[40:43]
  v_mfma_f32_16x16x32_bf16 v[48:51], v[160:163], v[64:67], v[48:51]
  v_mfma_f32_16x16x32_bf16 v[48:51], v[164:167], v[68:71], v[48:51]
  v_mfma_f32_16x16x32_bf16 v[48:51], v[168:171], v[72:75], v[48:51]
  v_mfma_f32_16x16x32_bf16 v[48:51], v[172:175], v[76:79], v[48:51]
  v_mfma_f32_16x16x32_bf16 v[56:59], v[176:179], v[64:67], v[56:59]
  v_mfma_f32_16x16x32_bf16 v[56:59], v[180:183], v[68:71], v[56:59]
  v_mfma_f32_16x16x32_bf16 v[56:59], v[184:187], v[72:75], v[56:59]
  v_mfma_f32_16x16x32_bf16 v[56:59], v[188:191], v[76:79], v[56:59]
  s_waitcnt lgkmcnt(0)
  v_mfma_f32_16x16x32_bf16 v[36:39], v[128:131], v[80:83], v[36:39]
  v_mfma_f32_16x16x32_bf16 v[36:39], v[132:135], v[84:87], v[36:39]
  v_mfma_f32_16x16x32_bf16 v[36:39], v[136:139], v[88:91], v[36:39]
  v_mfma_f32_16x16x32_bf16 v[36:39], v[140:143], v[92:95], v[36:39]
  v_cvt_pk_bf16_f32 v32, v32, v33
  v_cvt_pk_bf16_f32 v33, v34, v35
  ds_write_b64 v23, v[32:33]
  v_cvt_pk_bf16_f32 v40, v40, v41
  v_cvt_pk_bf16_f32 v41, v42, v43
  ds_write_b64 v24, v[40:41]
  v_cvt_pk_bf16_f32 v48, v48, v49
  v_cvt_pk_bf16_f32 v49, v50, v51
  ds_write_b64 v25, v[48:49]
  v_mfma_f32_16x16x32_bf16 v[44:47], v[144:147], v[80:83], v[44:47]
  v_mfma_f32_16x16x32_bf16 v[44:47], v[148:151], v[84:87], v[44:47]
  v_mfma_f32_16x16x32_bf16 v[44:47], v[152:155], v[88:91], v[44:47]
  v_mfma_f32_16x16x32_bf16 v[44:47], v[156:159], v[92:95], v[44:47]
  v_cvt_pk_bf16_f32 v56, v56, v57
  v_cvt_pk_bf16_f32 v57, v58, v59
  ds_write_b64 v26, v[56:57]
  s_waitcnt lgkmcnt(0)
  ds_read_b128 v[96:99], v27
  ds_read_b128 v[100:103], v27 offset:1024
  v_mfma_f32_16x16x32_bf16 v[52:55], v[160:163], v[80:83], v[52:55]
  v_mfma_f32_16x16x32_bf16 v[52:55], v[164:167], v[84:87], v[52:55]
  v_mfma_f32_16x16x32_bf16 v[52:55], v[168:171], v[88:91], v[52:55]
  v_mfma_f32_16x16x32_bf16 v[52:55], v[172:175], v[92:95], v[52:55]
  s_waitcnt lgkmcnt(1)
  buffer_store_dwordx4 v[96:99], v28, s[60:63], s12 offen sc1
  s_add_u32 s12, s12, 133120
  s_waitcnt lgkmcnt(0)
  buffer_store_dwordx4 v[100:103], v28, s[60:63], s12 offen sc1
  s_add_u32 s12, s12, 133120
  v_mfma_f32_16x16x32_bf16 v[60:63], v[176:179], v[80:83], v[60:63]
  v_mfma_f32_16x16x32_bf16 v[60:63], v[180:183], v[84:87], v[60:63]
  v_mfma_f32_16x16x32_bf16 v[60:63], v[184:187], v[88:91], v[60:63]
  v_mfma_f32_16x16x32_bf16 v[60:63], v[188:191], v[92:95], v[60:63]
  ds_read_b128 v[112:115], v6 offset:256
  ds_read_b128 v[116:119], v6 offset:272
  ds_read_b128 v[120:123], v6 offset:1280
  ds_read_b128 v[124:127], v6 offset:1296
  v_cvt_pk_bf16_f32 v36, v36, v37
  v_cvt_pk_bf16_f32 v37, v38, v39
  ds_write_b64 v23, v[36:37] offset:2048
  v_cvt_pk_bf16_f32 v44, v44, v45
  v_cvt_pk_bf16_f32 v45, v46, v47
  ds_write_b64 v24, v[44:45] offset:2048
  v_cvt_pk_bf16_f32 v52, v52, v53
  v_cvt_pk_bf16_f32 v53, v54, v55
  ds_write_b64 v25, v[52:53] offset:2048
  v_cvt_pk_bf16_f32 v60, v60, v61
  v_cvt_pk_bf16_f32 v61, v62, v63
  ds_write_b64 v26, v[60:61] offset:2048
  s_waitcnt lgkmcnt(0)
  ds_read_b128 v[104:107], v27 offset:2048
  ds_read_b128 v[108:111], v27 offset:3072
  v_max3_f32 v8, v112, v113, v114
  v_max3_f32 v8, v8, v115, v116
  v_max3_f32 v8, v8, v117, v118
  v_max_f32 v8, v8, v119
  s_waitcnt lgkmcnt(1)
  buffer_store_dwordx4 v[104:107], v28, s[60:63], s12 offen sc1
  s_add_u32 s12, s12, 133120
  s_waitcnt lgkmcnt(0)
  buffer_store_dwordx4 v[108:111], v28, s[60:63], s12 offen sc1
  v_add_f32 v9, v120, v121
  v_add_f32 v10, v122, v123
  v_add_f32 v11, v124, v125
  v_add_f32 v12, v126, v127
  v_add_f32 v9, v9, v10
  v_add_f32 v11, v11, v12
  v_add_f32 v9, v9, v11
  s_waitcnt vmcnt(0)
  s_barrier
  s_cmp_lg_u32 s3, 0
  s_cbranch_scc1 L_c1_done
  buffer_store_dwordx2 v[8:9], v29, s[60:63], s13 offen sc1
  s_branch L_c1_done
L_pv_fast:
  s_waitcnt lgkmcnt(4)
  v_mfma_f32_16x16x32_bf16 v[32:35], v[128:131], v[64:67], v[32:35]
  v_mfma_f32_16x16x32_bf16 v[32:35], v[132:135], v[68:71], v[32:35]
  v_mfma_f32_16x16x32_bf16 v[32:35], v[136:139], v[72:75], v[32:35]
  v_mfma_f32_16x16x32_bf16 v[32:35], v[140:143], v[76:79], v[32:35]
  v_mfma_f32_16x16x32_bf16 v[40:43], v[144:147], v[64:67], v[40:43]
  v_mfma_f32_16x16x32_bf16 v[40:43], v[148:151], v[68:71], v[40:43]
  v_mfma_f32_16x16x32_bf16 v[40:43], v[152:155], v[72:75], v[40:43]
  v_mfma_f32_16x16x32_bf16 v[40:43], v[156:159], v[76:79], v[40:43]
  v_mfma_f32_16x16x32_bf16 v[48:51], v[160:163], v[64:67], v[48:51]
  v_mfma_f32_16x16x32_bf16 v[48:51], v[164:167], v[68:71], v[48:51]
  v_mfma_f32_16x16x32_bf16 v[48:51], v[168:171], v[72:75], v[48:51]
  v_mfma_f32_16x16x32_bf16 v[48:51], v[172:175], v[76:79], v[48:51]
  v_mfma_f32_16x16x32_bf16 v[56:59], v[176:179], v[64:67], v[56:59]
  v_mfma_f32_16x16x32_bf16 v[56:59], v[180:183], v[68:71], v[56:59]
  v_mfma_f32_16x16x32_bf16 v[56:59], v[184:187], v[72:75], v[56:59]
  v_mfma_f32_16x16x32_bf16 v[56:59], v[188:191], v[76:79], v[56:59]
  s_waitcnt lgkmcnt(0)
  v_mfma_f32_16x16x32_bf16 v[36:39], v[128:131], v[80:83], v[36:39]
  v_mfma_f32_16x16x32_bf16 v[36:39], v[132:135], v[84:87], v[36:39]
  v_mfma_f32_16x16x32_bf16 v[36:39], v[136:139], v[88:91], v[36:39]
  v_mfma_f32_16x16x32_bf16 v[36:39], v[140:143], v[92:95], v[36:39]
  v_cvt_pk_bf16_f32 v32, v32, v33
  v_cvt_pk_bf16_f32 v33, v34, v35
  ds_write_b64 v23, v[32:33]
  v_cvt_pk_bf16_f32 v40, v40, v41
  v_cvt_pk_bf16_f32 v41, v42, v43
  ds_write_b64 v24, v[40:41]
  v_cvt_pk_bf16_f32 v48, v48, v49
  v_cvt_pk_bf16_f32 v49, v50, v51
  ds_write_b64 v25, v[48:49]
  v_mfma_f32_16x16x32_bf16 v[44:47], v[144:147], v[80:83], v[44:47]
  v_mfma_f32_16x16x32_bf16 v[44:47], v[148:151], v[84:87], v[44:47]
  v_mfma_f32_16x16x32_bf16 v[44:47], v[152:155], v[88:91], v[44:47]
  v_mfma_f32_16x16x32_bf16 v[44:47], v[156:159], v[92:95], v[44:47]
  v_cvt_pk_bf16_f32 v56, v56, v57
  v_cvt_pk_bf16_f32 v57, v58, v59
  ds_write_b64 v26, v[56:57]
  s_waitcnt lgkmcnt(0)
  ds_read_b128 v[96:99], v27
  ds_read_b128 v[100:103], v27 offset:1024
  v_mfma_f32_16x16x32_bf16 v[52:55], v[160:163], v[80:83], v[52:55]
  v_mfma_f32_16x16x32_bf16 v[52:55], v[164:167], v[84:87], v[52:55]
  v_mfma_f32_16x16x32_bf16 v[52:55], v[168:171], v[88:91], v[52:55]
  v_mfma_f32_16x16x32_bf16 v[52:55], v[172:175], v[92:95], v[52:55]
  s_waitcnt lgkmcnt(1)
  buffer_store_dwordx4 v[96:99], v28, s[60:63], s12 offen
  s_add_u32 s12, s12, 133120
  s_waitcnt lgkmcnt(0)
  buffer_store_dwordx4 v[100:103], v28, s[60:63], s12 offen
  s_add_u32 s12, s12, 133120
  v_mfma_f32_16x16x32_bf16 v[60:63], v[176:179], v[80:83], v[60:63]
  v_mfma_f32_16x16x32_bf16 v[60:63], v[180:183], v[84:87], v[60:63]
  v_mfma_f32_16x16x32_bf16 v[60:63], v[184:187], v[88:91], v[60:63]
  v_mfma_f32_16x16x32_bf16 v[60:63], v[188:191], v[92:95], v[60:63]
  ds_read_b128 v[112:115], v6 offset:256
  ds_read_b128 v[116:119], v6 offset:272
  ds_read_b128 v[120:123], v6 offset:1280
  ds_read_b128 v[124:127], v6 offset:1296
  v_cvt_pk_bf16_f32 v36, v36, v37
  v_cvt_pk_bf16_f32 v37, v38, v39
  ds_write_b64 v23, v[36:37] offset:2048
  v_cvt_pk_bf16_f32 v44, v44, v45
  v_cvt_pk_bf16_f32 v45, v46, v47
  ds_write_b64 v24, v[44:45] offset:2048
  v_cvt_pk_bf16_f32 v52, v52, v53
  v_cvt_pk_bf16_f32 v53, v54, v55
  ds_write_b64 v25, v[52:53] offset:2048
  v_cvt_pk_bf16_f32 v60, v60, v61
  v_cvt_pk_bf16_f32 v61, v62, v63
  ds_write_b64 v26, v[60:61] offset:2048
  s_waitcnt lgkmcnt(0)
  ds_read_b128 v[104:107], v27 offset:2048
  ds_read_b128 v[108:111], v27 offset:3072
  v_max3_f32 v8, v112, v113, v114
  v_max3_f32 v8, v8, v115, v116
  v_max3_f32 v8, v8, v117, v118
  v_max_f32 v8, v8, v119
  s_waitcnt lgkmcnt(1)
  buffer_store_dwordx4 v[104:107], v28, s[60:63], s12 offen
  s_add_u32 s12, s12, 133120
  s_waitcnt lgkmcnt(0)
  buffer_store_dwordx4 v[108:111], v28, s[60:63], s12 offen
  v_add_f32 v9, v120, v121
  v_add_f32 v10, v122, v123
  v_add_f32 v11, v124, v125
  v_add_f32 v12, v126, v127
  v_add_f32 v9, v9, v10
  v_add_f32 v11, v11, v12
  v_add_f32 v9, v9, v11
  s_waitcnt vmcnt(0)
  s_barrier
  s_cmp_lg_u32 s3, 0
  s_cbranch_scc1 L_c1_done
  buffer_store_dwordx2 v[8:9], v29, s[60:63], s13 offen
L_c1_done:
  v_lshlrev_b32 v16, 3, v30
  s_lshl_b32 s14, s4, 5
  s_lshl_b32 s13, s6, 1
  s_add_u32 s14, s14, s13
  s_mul_i32 s12, s14, 16640
  v_lshlrev_b32 v7, 10, v30
  v_lshl_add_u32 v7, v31, 4, v7
  v_add_u32 v6, 8192, v7
  s_lshl_b32 s13, s3, 7
  s_add_u32 s12, s12, s13
  s_add_u32 s12, s12, 4194304
  s_add_u32 s14, s12, 16640
  v_lshlrev_b32 v17, 4, v31
  v_lshl_add_u32 v17, v2, 2, v17
  v_bfe_u32 v4, v1, 3, 1
  v_lshl_add_u32 v17, v4, 13, v17
  s_lshl_b32 s95, s6, 4
  s_add_u32 s95, s95, s4
  s_lshl_b32 s94, s95, 10
  s_add_u32 s94, s94, s13
  s_add_u32 s94, s94, 1572864
  s_lshl_b32 s95, s95, 7
  s_add_u32 s95, s95, 131072
  v_lshlrev_b32 v18, 7, v1
  v_and_b32 v4, 0x1f7, v0
  v_mov_b32 v19, 2147483392
  v_cmp_eq_u32 vcc, 0, v4
  s_nop 1
  v_cndmask_b32 v18, v19, v18, vcc
  s_sleep 1
  s_mov_b32 s92, 0
Lp_21:
  buffer_load_dwordx2 v[32:33], v16, s[60:63], s93 offen offset:0 sc1
  buffer_load_dwordx2 v[34:35], v16, s[60:63], s93 offen offset:64 sc1
  buffer_load_dwordx2 v[36:37], v16, s[60:63], s93 offen offset:128 sc1
  buffer_load_dwordx2 v[38:39], v16, s[60:63], s93 offen offset:192 sc1
  s_waitcnt vmcnt(0)
  v_max_u32 v4, v32, v33
  v_max3_u32 v4, v4, v34, v35
  v_max3_u32 v4, v4, v36, v37
  v_max3_u32 v4, v4, v38, v39
  v_cmp_ne_u32 vcc, -1, v4
  s_add_u32 s92, s92, 1
  s_cmp_eq_u64 vcc, exec
  s_cbranch_scc1 Ld_22
  s_sleep 1
  s_cmp_lt_u32 s92, 60000
  s_cbranch_scc1 Lp_21
Ld_22:
  buffer_load_dwordx4 v[64:67], v7, s[60:63], s12 offen sc1
  buffer_load_dwordx4 v[68:71], v6, s[60:63], s12 offen sc1
  buffer_load_dwordx4 v[72:75], v7, s[60:63], s14 offen sc1
  buffer_load_dwordx4 v[76:79], v6, s[60:63], s14 offen sc1
  v_max_f32 v8, v32, v34
  v_max_f32 v10, v36, v38
  s_nop 1
  v_max_f32_dpp v8, v8, v8 row_ror:8 row_mask:0xf bank_mask:0xf
  v_max_f32_dpp v10, v10, v10 row_ror:8 row_mask:0xf bank_mask:0xf
  v_mov_b32 v12, v8
  v_mov_b32 v13, v10
  s_nop 0
  v_permlane16_swap_b32 v8, v12
  v_permlane16_swap_b32 v10, v13
  v_max_f32 v8, v8, v12
  v_max_f32 v10, v10, v13
  v_mov_b32 v12, v8
  v_mov_b32 v13, v10
  s_nop 0
  v_permlane32_swap_b32 v8, v12
  v_permlane32_swap_b32 v10, v13
  v_max_f32 v8, v8, v12
  v_max_f32 v10, v10, v13
  v_sub_f32 v32, v32, v8
  v_sub_f32 v34, v34, v8
  v_sub_f32 v36, v36, v10
  v_sub_f32 v38, v38, v10
  v_exp_f32 v32, v32
  v_exp_f32 v34, v34
  v_exp_f32 v36, v36
  v_exp_f32 v38, v38
  s_nop 0
  v_mul_f32 v9, v32, v33
  v_mul_f32 v11, v36, v37
  v_fmac_f32 v9, v34, v35
  v_fmac_f32 v11, v38, v39
  s_nop 1
  v_add_f32_dpp v9, v9, v9 row_ror:8 row_mask:0xf bank_mask:0xf
  v_add_f32_dpp v11, v11, v11 row_ror:8 row_mask:0xf bank_mask:0xf
  v_mov_b32 v12, v9
  v_mov_b32 v13, v11
  s_nop 0
  v_permlane16_swap_b32 v9, v12
  v_permlane16_swap_b32 v11, v13
  v_add_f32 v9, v9, v12
  v_add_f32 v11, v11, v13
  v_mov_b32 v12, v9
  v_mov_b32 v13, v11
  s_nop 0
  v_permlane32_swap_b32 v9, v12
  v_permlane32_swap_b32 v11, v13
  v_add_f32 v9, v9, v12
  v_add_f32 v11, v11, v13
  v_cmp_eq_u32 vcc, 8, v1
  s_nop 1
  v_cndmask_b32 v8, v8, v10, vcc
  v_cndmask_b32 v9, v9, v11, vcc
  buffer_store_dwordx2 v[8:9], v18, s[60:63], s95 offen sc1
  s_waitcnt vmcnt(4)
  v_lshlrev_b32 v12, 16, v64
  v_and_b32 v13, 0xffff0000, v64
  v_mul_f32 v40, v32, v12
  v_mul_f32 v41, v32, v13
  v_lshlrev_b32 v12, 16, v65
  v_and_b32 v13, 0xffff0000, v65
  v_mul_f32 v42, v32, v12
  v_mul_f32 v43, v32, v13
  v_lshlrev_b32 v12, 16, v66
  v_and_b32 v13, 0xffff0000, v66
  v_mul_f32 v44, v32, v12
  v_mul_f32 v45, v32, v13
  v_lshlrev_b32 v12, 16, v67
  v_and_b32 v13, 0xffff0000, v67
  v_mul_f32 v46, v32, v12
  v_mul_f32 v47, v32, v13
  s_waitcnt vmcnt(3)
  v_lshlrev_b32 v12, 16, v68
  v_and_b32 v13, 0xffff0000, v68
  v_fmac_f32 v40, v34, v12
  v_fmac_f32 v41, v34, v13
  v_lshlrev_b32 v12, 16, v69
  v_and_b32 v13, 0xffff0000, v69
  v_fmac_f32 v42, v34, v12
  v_fmac_f32 v43, v34, v13
  v_lshlrev_b32 v12, 16, v70
  v_and_b32 v13, 0xffff0000, v70
  v_fmac_f32 v44, v34, v12
  v_fmac_f32 v45, v34, v13
  v_lshlrev_b32 v12, 16, v71
  v_and_b32 v13, 0xffff0000, v71
  v_fmac_f32 v46, v34, v12
  v_fmac_f32 v47, v34, v13
  s_waitcnt vmcnt(2)
  v_lshlrev_b32 v12, 16, v72
  v_and_b32 v13, 0xffff0000, v72
  v_mul_f32 v48, v36, v12
  v_mul_f32 v49, v36, v13
  v_lshlrev_b32 v12, 16, v73
  v_and_b32 v13, 0xffff0000, v73
  v_mul_f32 v50, v36, v12
  v_mul_f32 v51, v36, v13
  v_lshlrev_b32 v12, 16, v74
  v_and_b32 v13, 0xffff0000, v74
  v_mul_f32 v52, v36, v12
  v_mul_f32 v53, v36, v13
  v_lshlrev_b32 v12, 16, v75
  v_and_b32 v13, 0xffff0000, v75
  v_mul_f32 v54, v36, v12
  v_mul_f32 v55, v36, v13
  s_waitcnt vmcnt(1)
  v_lshlrev_b32 v12, 16, v76
  v_and_b32 v13, 0xffff0000, v76
  v_fmac_f32 v48, v38, v12
  v_fmac_f32 v49, v38, v13
  v_lshlrev_b32 v12, 16, v77
  v_and_b32 v13, 0xffff0000, v77
  v_fmac_f32 v50, v38, v12
  v_fmac_f32 v51, v38, v13
  v_lshlrev_b32 v12, 16, v78
  v_and_b32 v13, 0xffff0000, v78
  v_fmac_f32 v52, v38, v12
  v_fmac_f32 v53, v38, v13
  v_lshlrev_b32 v12, 16, v79
  v_and_b32 v13, 0xffff0000, v79
  v_fmac_f32 v54, v38, v12
  v_fmac_f32 v55, v38, v13
  s_nop 1
  v_permlane16_swap_b32 v40, v42
  v_permlane16_swap_b32 v41, v43
  v_permlane16_swap_b32 v44, v46
  v_permlane16_swap_b32 v45, v47
  v_permlane16_swap_b32 v48, v50
  v_permlane16_swap_b32 v49, v51
  v_permlane16_swap_b32 v52, v54
  v_permlane16_swap_b32 v53, v55
  v_add_f32 v40, v40, v42
  v_add_f32 v41, v41, v43
  v_add_f32 v44, v44, v46
  v_add_f32 v45, v45, v47
  v_add_f32 v48, v48, v50
  v_add_f32 v49, v49, v51
  v_add_f32 v52, v52, v54
  v_add_f32 v53, v53, v55
  s_nop 0
  v_permlane32_swap_b32 v40, v44
  v_permlane32_swap_b32 v41, v45
  v_permlane32_swap_b32 v48, v52
  v_permlane32_swap_b32 v49, v53
  v_add_f32 v40, v40, v44
  v_add_f32 v41, v41, v45
  v_add_f32 v48, v48, v52
  v_add_f32 v49, v49, v53
  v_cmp_lt_u32 vcc, 7, v3
  v_add_f32_dpp v40, v40, v40 row_ror:8 row_mask:0xf bank_mask:0xf
  v_add_f32_dpp v41, v41, v41 row_ror:8 row_mask:0xf bank_mask:0xf
  v_add_f32_dpp v48, v48, v48 row_ror:8 row_mask:0xf bank_mask:0xf
  v_add_f32_dpp v49, v49, v49 row_ror:8 row_mask:0xf bank_mask:0xf
  v_cvt_pk_bf16_f32 v40, v40, v41
  v_cvt_pk_bf16_f32 v48, v48, v49
  v_cndmask_b32 v40, v40, v48, vcc
  buffer_store_dword v40, v17, s[60:63], s94 offen sc1
  s_waitcnt vmcnt(0)
  s_barrier
  s_cmp_eq_u32 s10, 0
  s_cbranch_scc1 L_down
  v_mul_u32_u24 v4, 3456, v30
  v_and_b32 v6, 1, v2
  s_and_b32 s12, s3, 1
  s_lshl_b32 s12, s12, 1
  v_add_u32 v6, s12, v6
  v_lshlrev_b32 v6, 1, v6
  v_xor_b32 v6, v6, v31
  v_lshl_add_u32 v4, v6, 4, v4
  s_mul_i32 s12, s11, 160
  s_and_b32 s14, s3, 3
  s_lshl_b32 s13, s14, 3
  s_add_u32 s12, s12, s13
  s_mul_i32 s12, s12, 3456
  s_lshl_b32 s13, s9, 7
  s_add_u32 s12, s12, s13
  s_lshl_b32 s13, s14, 10
  s_cmp_ge_u32 s3, 4
  s_cbranch_scc1 L_up_w3
  s_add_u32 s13, s13, 5120
  s_mov_b32 m0, s13
  s_add_u32 s13, s13, 4096
  buffer_load_dwordx4 v4, s[40:43], s12 offen nt lds
  s_add_u32 s12, s12, 110592
  s_mov_b32 m0, s13
  s_add_u32 s13, s13, 4096
  buffer_load_dwordx4 v4, s[40:43], s12 offen nt lds
  s_add_u32 s12, s12, 110592
  s_mov_b32 m0, s13
  s_add_u32 s13, s13, 4096
  buffer_load_dwordx4 v4, s[40:43], s12 offen nt lds
  s_add_u32 s12, s12, 110592
  s_mov_b32 m0, s13
  s_add_u32 s13, s13, 4096
  buffer_load_dwordx4 v4, s[40:43], s12 offen nt lds
  s_add_u32 s12, s12, 110592
  s_mov_b32 m0, s13
  s_add_u32 s13, s13, 4096
  buffer_load_dwordx4 v4, s[40:43], s12 offen nt lds
  s_add_u32 s12, s12, 110592
  s_branch L_up_ld
L_up_w3:
  s_add_u32 s13, s13, 25600
  s_mov_b32 m0, s13
  s_add_u32 s13, s13, 4096
  buffer_load_dwordx4 v4, s[44:47], s12 offen nt lds
  s_add_u32 s12, s12, 110592
  s_mov_b32 m0, s13
  s_add_u32 s13, s13, 4096
  buffer_load_dwordx4 v4, s[44:47], s12 offen nt lds
  s_add_u32 s12, s12, 110592
  s_mov_b32 m0, s13
  s_add_u32 s13, s13, 4096
  buffer_load_dwordx4 v4, s[44:47], s12 offen nt lds
  s_add_u32 s12, s12, 110592
  s_mov_b32 m0, s13
  s_add_u32 s13, s13, 4096
  buffer_load_dwordx4 v4, s[44:47], s12 offen nt lds
  s_add_u32 s12, s12, 110592
  s_mov_b32 m0, s13
  s_add_u32 s13, s13, 4096
  buffer_load_dwordx4 v4, s[44:47], s12 offen nt lds
  s_add_u32 s12, s12, 110592
L_up_ld:
  v_bfe_u32 v4, v1, 3, 1
  v_and_b32 v6, 1, v2
  v_lshl_add_u32 v4, v6, 1, v4
  v_xor_b32 v4, s14, v4
  v_lshlrev_b32 v16, 5, v4
  v_bfe_u32 v4, v1, 2, 2
  v_lshl_add_u32 v4, v2, 3, v4
  v_lshl_add_u32 v16, v4, 7, v16
  v_and_b32 v4, 3, v1
  v_lshl_add_u32 v16, v4, 3, v16
  s_lshr_b32 s12, s3, 2
  s_mul_i32 s12, s12, 20480
  v_add_u32 v16, s12, v16
  v_and_b32 v17, 3, v3
  v_min_u32 v17, 2, v17
  v_mul_u32_u24 v17, 320, v17
  v_lshl_add_u32 v17, v2, 4, v17
  v_lshlrev_b32 v18, 2, v4
  v_mov_b32 v4, 2147483392
  v_cmp_gt_u32 vcc, 16, v1
  s_lshl_b32 s93, s4, 4
  s_add_u32 s93, s93, s6
  v_cndmask_b32 v19, v4, v5, vcc
  s_lshl_b32 s93, s93, 11
  s_andn2_b32 s94, s93, 0x1fff
  s_lshl_b32 s13, s3, 8
  s_add_u32 s93, s93, s13
  s_add_u32 s93, s93, 1048576
  s_lshl_b32 s13, s11, 8
  s_add_u32 s94, s94, s13
  s_add_u32 s94, s94, 1048576
  v_lshlrev_b32 v20, 11, v2
  v_lshl_add_u32 v20, v3, 4, v20
  v_min_u32 v21, 39, v1
  v_mov_b32 v8, 0
  v_mov_b32 v9, 0
  v_mov_b32 v10, 0
  v_mov_b32 v11, 0
  s_sub_u32 s12, s3, 1
  s_cmp_ge_u32 s12, 2
  s_cbranch_scc1 L_up_nx
  v_lshlrev_b32 v22, 3, v21
  s_mul_i32 s13, s12, 1280
  s_mul_i32 s14, s11, 320
  s_add_u32 s13, s13, s14
  buffer_load_dwordx2 v[194:195], v22, s[16:19], s13 offen
  L_up_nx:
  s_cmp_lg_u32 s3, 3
  s_cbranch_scc1 L_up_n1
  v_mov_b32 v12, 0x3f803f80
  v_mov_b32 v13, 0x3f803f80
  v_lshlrev_b32 v4, 3, v21
  ds_write_b64 v4, v[12:13] offset:2944
  L_up_n1:
  s_cmp_lg_u32 s3, 0
  s_cbranch_scc1 L_up_n0
  v_lshrrev_b32 v4, 2, v3
  v_lshlrev_b32 v4, 11, v4
  v_bfe_u32 v6, v3, 1, 1
  v_lshl_add_u32 v4, v6, 10, v4
  v_and_b32 v6, 1, v3
  v_lshl_add_u32 v4, v6, 7, v4
  buffer_load_dword v194, v4, s[60:63], s94 offen sc1 nt
  L_up_n0:
  s_waitcnt vmcnt(0) lgkmcnt(0)
  s_barrier
  ds_read_b64_tr_b16 v[96:97], v16 offset:5120
  ds_read_b64_tr_b16 v[98:99], v16 offset:5632
  ds_read_b64_tr_b16 v[100:101], v16 offset:9216
  ds_read_b64_tr_b16 v[102:103], v16 offset:9728
  ds_read_b64_tr_b16 v[104:105], v16 offset:13312
  ds_read_b64_tr_b16 v[106:107], v16 offset:13824
  ds_read_b64_tr_b16 v[108:109], v16 offset:17408
  ds_read_b64_tr_b16 v[110:111], v16 offset:17920
  ds_read_b64_tr_b16 v[112:113], v16 offset:21504
  ds_read_b64_tr_b16 v[114:115], v16 offset:22016
  s_cmp_ge_u32 s12, 2
  s_cbranch_scc1 L_up_mm
  v_lshlrev_b32 v7, 4, v21
  s_mul_i32 s13, s12, 2560
  s_mul_i32 s14, s11, 640
  s_add_u32 s13, s13, s14
  s_add_u32 s13, s13, 196608
  s_mul_i32 s14, s12, 320
  v_add_u32 v22, s14, v22
  s_mov_b32 s92, 0
Lp_24:
  s_add_u32 s14, s13, 0
  buffer_load_dwordx4 v[32:35], v7, s[60:63], s14 offen sc1
  s_add_u32 s14, s13, 5120
  buffer_load_dwordx4 v[36:39], v7, s[60:63], s14 offen sc1
  s_add_u32 s14, s13, 10240
  buffer_load_dwordx4 v[40:43], v7, s[60:63], s14 offen sc1
  s_add_u32 s14, s13, 15360
  buffer_load_dwordx4 v[44:47], v7, s[60:63], s14 offen sc1
  s_add_u32 s14, s13, 20480
  buffer_load_dwordx4 v[48:51], v7, s[60:63], s14 offen sc1
  s_add_u32 s14, s13, 25600
  buffer_load_dwordx4 v[52:55], v7, s[60:63], s14 offen sc1
  s_add_u32 s14, s13, 30720
  buffer_load_dwordx4 v[56:59], v7, s[60:63], s14 offen sc1
  s_add_u32 s14, s13, 35840
  buffer_load_dwordx4 v[60:63], v7, s[60:63], s14 offen sc1
  s_waitcnt vmcnt(0)
  v_max_u32 v4, v32, v33
  v_max3_u32 v4, v4, v34, v35
  v_max3_u32 v4, v4, v36, v37
  v_max3_u32 v4, v4, v38, v39
  v_max3_u32 v4, v4, v40, v41
  v_max3_u32 v4, v4, v42, v43
  v_max3_u32 v4, v4, v44, v45
  v_max3_u32 v4, v4, v46, v47
  v_max3_u32 v4, v4, v48, v49
  v_max3_u32 v4, v4, v50, v51
  v_max3_u32 v4, v4, v52, v53
  v_max3_u32 v4, v4, v54, v55
  v_max3_u32 v4, v4, v56, v57
  v_max3_u32 v4, v4, v58, v59
  v_max3_u32 v4, v4, v60, v61
  v_max3_u32 v4, v4, v62, v63
  v_cmp_ne_u32 vcc, -1, v4
  s_add_u32 s92, s92, 1
  s_cmp_eq_u64 vcc, exec
  s_cbranch_scc1 Ld_25
  s_sleep 4
  s_cmp_lt_u32 s92, 60000
  s_cbranch_scc1 Lp_24
Ld_25:
  v_add_f32 v32, v32, v36
  v_add_f32 v33, v33, v37
  v_add_f32 v34, v34, v38
  v_add_f32 v35, v35, v39
  v_add_f32 v40, v40, v44
  v_add_f32 v41, v41, v45
  v_add_f32 v42, v42, v46
  v_add_f32 v43, v43, v47
  v_add_f32 v48, v48, v52
  v_add_f32 v49, v49, v53
  v_add_f32 v50, v50, v54
  v_add_f32 v51, v51, v55
  v_add_f32 v56, v56, v60
  v_add_f32 v57, v57, v61
  v_add_f32 v58, v58, v62
  v_add_f32 v59, v59, v63
  v_add_f32 v32, v32, v40
  v_add_f32 v33, v33, v41
  v_add_f32 v34, v34, v42
  v_add_f32 v35, v35, v43
  v_add_f32 v48, v48, v56
  v_add_f32 v49, v49, v57
  v_add_f32 v50, v50, v58
  v_add_f32 v51, v51, v59
  v_add_f32 v32, v32, v48
  v_add_f32 v33, v33, v49
  v_add_f32 v34, v34, v50
  v_add_f32 v35, v35, v51
  v_cvt_pk_bf16_f32 v8, v32, v33
  v_cvt_pk_bf16_f32 v9, v34, v35
  v_lshlrev_b32 v36, 16, v194
  v_and_b32 v37, 0xffff0000, v194
  v_lshlrev_b32 v38, 16, v195
  v_and_b32 v39, 0xffff0000, v195
  v_lshlrev_b32 v32, 16, v8
  v_and_b32 v33, 0xffff0000, v8
  v_lshlrev_b32 v34, 16, v9
  v_and_b32 v35, 0xffff0000, v9
  v_add_f32 v32, v32, v36
  v_add_f32 v33, v33, v37
  v_add_f32 v34, v34, v38
  v_add_f32 v35, v35, v39
  v_cvt_pk_bf16_f32 v8, v32, v33
  v_cvt_pk_bf16_f32 v9, v34, v35
  ds_write_b64 v22, v[8:9] offset:2304
  s_waitcnt lgkmcnt(0)
  s_mov_b64 exec, 1
  ds_add_u32 v192, v193 offset:68
  s_mov_b64 exec, -1
  v_mov_b32 v8, 0
  v_mov_b32 v9, 0
L_up_mm:
  v_mov_b32 v12, 0
  v_mov_b32 v13, 0
  v_mov_b32 v14, 0
  v_mov_b32 v15, 0
  s_mov_b32 s100, 0xaaaaaaaa
  s_mov_b32 s101, 0xaaaaaaaa
Lw_27:
  ds_read_b32 v4, v192 offset:68
  s_waitcnt lgkmcnt(0)
  v_cmp_gt_u32 vcc, 2, v4
  s_cbranch_vccnz Lw_27
  ds_read_b128 v[32:35], v17 offset:2304
  ds_read_b128 v[36:39], v17 offset:2368
  ds_read_b128 v[40:43], v17 offset:2432
  ds_read_b128 v[44:47], v17 offset:2496
  ds_read_b128 v[48:51], v17 offset:2560
  s_waitcnt lgkmcnt(4)
  v_mfma_f32_16x16x32_bf16 v[12:15], v[32:35], v[32:35], v[12:15]
  v_mfma_f32_16x16x32_bf16 v[8:11], v[32:35], v[96:99], v[8:11]
  s_waitcnt lgkmcnt(3)
  v_mfma_f32_16x16x32_bf16 v[12:15], v[36:39], v[36:39], v[12:15]
  v_mfma_f32_16x16x32_bf16 v[8:11], v[36:39], v[100:103], v[8:11]
  s_waitcnt lgkmcnt(2)
  v_mfma_f32_16x16x32_bf16 v[12:15], v[40:43], v[40:43], v[12:15]
  v_mfma_f32_16x16x32_bf16 v[8:11], v[40:43], v[104:107], v[8:11]
  s_waitcnt lgkmcnt(1)
  v_mfma_f32_16x16x32_bf16 v[12:15], v[44:47], v[44:47], v[12:15]
  v_mfma_f32_16x16x32_bf16 v[8:11], v[44:47], v[108:111], v[8:11]
  s_waitcnt lgkmcnt(0)
  v_mfma_f32_16x16x32_bf16 v[12:15], v[48:51], v[48:51], v[12:15]
  v_mfma_f32_16x16x32_bf16 v[8:11], v[48:51], v[112:115], v[8:11]
  s_nop 7
  v_cndmask_b32 v11, v12, v13, s[100:101]
  s_cmp_eq_u32 s15, 1
  s_cbranch_scc1 L_u_fast
  buffer_store_dwordx4 v[8:11], v19, s[60:63], s93 offen sc1
  s_branch L_u_done
  L_u_fast:
  buffer_store_dwordx4 v[8:11], v19, s[60:63], s93 offen
  L_u_done:
  s_cmp_lg_u32 s3, 0
  s_cbranch_scc1 L_fin
  v_lshlrev_b32 v16, 5, v2
  v_lshl_add_u32 v16, v3, 1, v16
  v_and_b32 v4, 0x21, v1
  v_mov_b32 v6, 2147483392
  v_cmp_eq_u32 vcc, 0, v4
  s_lshl_b32 s13, s9, 2
  s_add_u32 s13, s13, s11
  v_cndmask_b32 v16, v6, v16, vcc
  s_lshl_b32 s13, s13, 7
  s_add_u32 s13, s13, 262144
  s_sleep 2
  s_mov_b32 s92, 0
Lp_28:
  buffer_load_dwordx4 v[32:35], v20, s[60:63], s94 offen sc1
  buffer_load_dwordx4 v[36:39], v20, s[60:63], s94 offen offset:1024 sc1
  s_waitcnt vmcnt(0)
  v_max_u32 v4, v32, v33
  v_max3_u32 v4, v4, v34, v35
  v_max3_u32 v4, v4, v36, v37
  v_max3_u32 v4, v4, v38, v39
  v_cmp_ne_u32 vcc, -1, v4
  s_add_u32 s92, s92, 1
  s_cmp_eq_u64 vcc, exec
  s_cbranch_scc1 Ld_29
  s_sleep 1
  s_cmp_lt_u32 s92, 60000
  s_cbranch_scc1 Lp_28
Ld_29:
  v_mov_b32 v40, v32
  v_mov_b32 v41, v33
  v_mov_b32 v42, v34
  v_mov_b32 v43, v35
  v_mov_b32 v44, v36
  v_mov_b32 v45, v37
  v_mov_b32 v46, v38
  v_permlane16_swap_b32 v32, v40
  v_permlane16_swap_b32 v33, v41
  v_permlane16_swap_b32 v34, v42
  v_permlane16_swap_b32 v35, v43
  v_permlane16_swap_b32 v36, v44
  v_permlane16_swap_b32 v37, v45
  v_permlane16_swap_b32 v38, v46
  v_add_f32 v32, v32, v40
  v_add_f32 v33, v33, v41
  v_add_f32 v34, v34, v42
  v_add_f32 v35, v35, v43
  v_add_f32 v36, v36, v44
  v_add_f32 v37, v37, v45
  v_add_f32 v38, v38, v46
  v_mov_b32 v40, v32
  v_mov_b32 v41, v33
  v_mov_b32 v42, v34
  v_mov_b32 v43, v35
  v_mov_b32 v44, v36
  v_mov_b32 v45, v37
  v_mov_b32 v46, v38
  v_permlane32_swap_b32 v32, v40
  v_permlane32_swap_b32 v33, v41
  v_permlane32_swap_b32 v34, v42
  v_permlane32_swap_b32 v35, v43
  v_permlane32_swap_b32 v36, v44
  v_permlane32_swap_b32 v37, v45
  v_permlane32_swap_b32 v38, v46
  v_add_f32 v32, v32, v40
  v_add_f32 v33, v33, v41
  v_add_f32 v34, v34, v42
  v_add_f32 v35, v35, v43
  v_add_f32 v36, v36, v44
  v_add_f32 v37, v37, v45
  v_add_f32 v38, v38, v46
  v_mov_b32_dpp v40, v35 quad_perm:[2,2,2,2] row_mask:0xf bank_mask:0xf
  v_mov_b32_dpp v41, v35 quad_perm:[0,0,0,0] row_mask:0xf bank_mask:0xf
  v_mov_b32_dpp v42, v35 quad_perm:[3,3,3,3] row_mask:0xf bank_mask:0xf
  v_mov_b32_dpp v43, v35 quad_perm:[1,1,1,1] row_mask:0xf bank_mask:0xf
  v_mul_f32 v40, 0x3acccccd, v40
  v_mul_f32 v41, 0x3acccccd, v41
  v_mul_f32 v42, 0x3acccccd, v42
  v_mul_f32 v43, 0x3acccccd, v43
  v_fma_f32 v41, -v40, v40, v41
  v_fma_f32 v43, -v42, v42, v43
  v_max_f32 v41, 0, v41
  v_max_f32 v43, 0, v43
  v_add_f32 v41, 0x3727c5ac, v41
  v_add_f32 v43, 0x3727c5ac, v43
  v_rsq_f32 v41, v41
  v_rsq_f32 v43, v43
  v_fma_f32 v32, -v40, v34, v32
  v_fma_f32 v33, -v42, v34, v33
  v_fma_f32 v36, -v40, v38, v36
  v_fma_f32 v37, -v42, v38, v37
  v_mul_f32 v32, v32, v41
  v_mul_f32 v33, v33, v43
  v_mul_f32 v36, v36, v41
  v_mul_f32 v37, v37, v43
  v_cvt_pk_bf16_f32 v8, v32, v33
  v_cvt_pk_bf16_f32 v9, v36, v37
  v_lshlrev_b32 v32, 16, v8
  v_and_b32 v33, 0xffff0000, v8
  v_lshlrev_b32 v34, 16, v9
  v_and_b32 v35, 0xffff0000, v9
  v_mul_f32 v36, 0xbfb8aa3b, v32
  v_mul_f32 v37, 0xbfb8aa3b, v33
  v_exp_f32 v36, v36
  v_exp_f32 v37, v37
  s_nop 0
  v_add_f32 v36, 1.0, v36
  v_add_f32 v37, 1.0, v37
  v_rcp_f32 v36, v36
  v_rcp_f32 v37, v37
  s_nop 0
  v_mul_f32 v32, v32, v36
  v_mul_f32 v33, v33, v37
  v_cvt_pk_bf16_f32 v8, v32, v33
  v_lshlrev_b32 v32, 16, v8
  v_and_b32 v33, 0xffff0000, v8
  v_mul_f32 v32, v32, v34
  v_mul_f32 v33, v33, v35
  v_cmp_eq_u32 vcc, 1, v2
  s_nop 0
  v_mov_b32_dpp v34, v32 row_ror:15 row_mask:0xf bank_mask:0xf
  v_mov_b32_dpp v35, v33 row_ror:15 row_mask:0xf bank_mask:0xf
  v_cvt_pk_bf16_f32 v8, v32, v34
  v_cvt_pk_bf16_f32 v9, v33, v35
  v_cndmask_b32 v8, v8, v9, vcc
  buffer_store_dword v8, v16, s[60:63], s13 offen sc1
  s_branch L_fin
L_down:
  v_lshrrev_b32 v4, 2, v1
  v_mul_u32_u24 v4, 1280, v4
  v_and_b32 v6, 3, v1
  v_lshl_add_u32 v4, v6, 4, v4
  s_mul_i32 s12, s3, 20480
  s_lshl_b32 s13, s9, 6
  s_add_u32 s12, s12, s13
  s_add_u32 s12, s12, 0
  s_lshl_b32 s13, s3, 10
  s_add_u32 s13, s13, 48128
  s_mov_b32 m0, s13
  s_add_u32 s13, s13, 8192
  buffer_load_dwordx4 v4, s[48:51], s12 offen nt lds
  s_add_u32 s12, s12, 163840
  s_mov_b32 m0, s13
  s_add_u32 s13, s13, 8192
  buffer_load_dwordx4 v4, s[48:51], s12 offen nt lds
  s_add_u32 s12, s12, 163840
  s_mov_b32 m0, s13
  s_add_u32 s13, s13, 8192
  buffer_load_dwordx4 v4, s[48:51], s12 offen nt lds
  s_add_u32 s12, s12, 163840
  s_mov_b32 m0, s13
  s_add_u32 s13, s13, 8192
  buffer_load_dwordx4 v4, s[48:51], s12 offen nt lds
  s_add_u32 s12, s12, 163840
  s_mov_b32 m0, s13
  s_add_u32 s13, s13, 8192
  buffer_load_dwordx4 v4, s[48:51], s12 offen nt lds
  s_add_u32 s12, s12, 163840
  s_mov_b32 m0, s13
  s_add_u32 s13, s13, 8192
  buffer_load_dwordx4 v4, s[48:51], s12 offen nt lds
  s_add_u32 s12, s12, 163840
  s_mov_b32 m0, s13
  s_add_u32 s13, s13, 8192
  buffer_load_dwordx4 v4, s[48:51], s12 offen nt lds
  s_add_u32 s12, s12, 163840
  s_mov_b32 m0, s13
  s_add_u32 s13, s13, 8192
  buffer_load_dwordx4 v4, s[48:51], s12 offen nt lds
  s_add_u32 s12, s12, 163840
  s_mov_b32 m0, s13
  s_add_u32 s13, s13, 8192
  buffer_load_dwordx4 v4, s[48:51], s12 offen nt lds
  s_add_u32 s12, s12, 163840
  s_mov_b32 m0, s13
  s_add_u32 s13, s13, 8192
  buffer_load_dwordx4 v4, s[48:51], s12 offen nt lds
  s_add_u32 s12, s12, 163840
  s_mov_b32 m0, s13
  s_add_u32 s13, s13, 8192
  buffer_load_dwordx4 v4, s[48:51], s12 offen nt lds
  s_add_u32 s12, s12, 163840
L_dn_ld:
  v_bfe_u32 v4, v1, 2, 2
  v_lshl_add_u32 v4, v2, 3, v4
  v_lshlrev_b32 v16, 6, v4
  v_lshl_add_u32 v16, v6, 3, v16
  s_lshl_b32 s12, s3, 11
  s_add_u32 s12, s12, 48128
  v_add_u32 v16, s12, v16
  v_add_u32 v17, 0x10000, v16
  v_and_b32 v18, 1, v3
  v_lshlrev_b32 v18, 5, v18
  v_and_b32 v4, 1, v2
  v_lshl_add_u32 v18, v4, 4, v18
  v_lshrrev_b32 v4, 1, v2
  v_lshl_add_u32 v18, v4, 7, v18
  v_add_u32 v23, 4096, v18
  v_add_u32 v24, 8192, v18
  s_lshl_b32 s93, s3, 8
  s_add_u32 s93, s93, 262144
  s_cmp_lt_u32 s3, 6
  s_cselect_b32 s94, 12288, 0
  s_add_u32 s94, s94, s93
  s_lshl_b32 s14, s3, 8
  v_lshl_add_u32 v19, v1, 4, s14
  v_mov_b32 v8, 0
  v_mov_b32 v9, 0
  v_mov_b32 v10, 0
  v_mov_b32 v11, 0
  v_mov_b32 v12, 0
  v_mov_b32 v13, 0
  v_mov_b32 v14, 0
  v_mov_b32 v15, 0
  s_cmp_lg_u32 s3, 1
  s_cbranch_scc1 L_dn_nx
  v_lshrrev_b32 v6, 3, v3
  v_mul_u32_u24 v7, 2560, v6
  v_lshl_add_u32 v7, v31, 4, v7
  v_mul_u32_u24 v20, 1280, v6
  v_lshl_add_u32 v20, v31, 3, v20
  v_lshlrev_b32 v22, 3, v3
  s_lshl_b32 s12, s9, 6
  buffer_load_dwordx2 v[194:195], v20, s[16:19], s12 offen
  L_dn_nx:
  s_waitcnt vmcnt(0) lgkmcnt(0)
  s_barrier
  ds_read_b64_tr_b16 v[96:97], v16 offset:0
  ds_read_b64_tr_b16 v[98:99], v16 offset:256
  ds_read_b64_tr_b16 v[100:101], v16 offset:32
  ds_read_b64_tr_b16 v[102:103], v16 offset:288
  ds_read_b64_tr_b16 v[104:105], v16 offset:16384
  ds_read_b64_tr_b16 v[106:107], v16 offset:16640
  ds_read_b64_tr_b16 v[108:109], v16 offset:16416
  ds_read_b64_tr_b16 v[110:111], v16 offset:16672
  ds_read_b64_tr_b16 v[112:113], v16 offset:32768
  ds_read_b64_tr_b16 v[114:115], v16 offset:33024
  ds_read_b64_tr_b16 v[116:117], v16 offset:32800
  ds_read_b64_tr_b16 v[118:119], v16 offset:33056
  ds_read_b64_tr_b16 v[120:121], v16 offset:49152
  ds_read_b64_tr_b16 v[122:123], v16 offset:49408
  ds_read_b64_tr_b16 v[124:125], v16 offset:49184
  ds_read_b64_tr_b16 v[126:127], v16 offset:49440
  ds_read_b64_tr_b16 v[128:129], v17 offset:0
  ds_read_b64_tr_b16 v[130:131], v17 offset:256
  ds_read_b64_tr_b16 v[132:133], v17 offset:32
  ds_read_b64_tr_b16 v[134:135], v17 offset:288
  ds_read_b64_tr_b16 v[136:137], v17 offset:16384
  ds_read_b64_tr_b16 v[138:139], v17 offset:16640
  ds_read_b64_tr_b16 v[140:141], v17 offset:16416
  ds_read_b64_tr_b16 v[142:143], v17 offset:16672
  ds_read_b64_tr_b16 v[144:145], v17 offset:32768
  ds_read_b64_tr_b16 v[146:147], v17 offset:33024
  ds_read_b64_tr_b16 v[148:149], v17 offset:32800
  ds_read_b64_tr_b16 v[150:151], v17 offset:33056
  s_cmp_lg_u32 s3, 1
  s_cbranch_scc1 L_dn_e
  s_lshl_b32 s13, s9, 7
  s_add_u32 s13, s13, 196608
  s_mov_b32 s92, 0
Lp_31:
  s_add_u32 s14, s13, 0
  buffer_load_dwordx4 v[32:35], v7, s[60:63], s14 offen sc1
  s_add_u32 s14, s13, 5120
  buffer_load_dwordx4 v[36:39], v7, s[60:63], s14 offen sc1
  s_add_u32 s14, s13, 10240
  buffer_load_dwordx4 v[40:43], v7, s[60:63], s14 offen sc1
  s_add_u32 s14, s13, 15360
  buffer_load_dwordx4 v[44:47], v7, s[60:63], s14 offen sc1
  s_add_u32 s14, s13, 20480
  buffer_load_dwordx4 v[48:51], v7, s[60:63], s14 offen sc1
  s_add_u32 s14, s13, 25600
  buffer_load_dwordx4 v[52:55], v7, s[60:63], s14 offen sc1
  s_add_u32 s14, s13, 30720
  buffer_load_dwordx4 v[56:59], v7, s[60:63], s14 offen sc1
  s_add_u32 s14, s13, 35840
  buffer_load_dwordx4 v[60:63], v7, s[60:63], s14 offen sc1
  s_waitcnt vmcnt(0)
  v_max_u32 v4, v32, v33
  v_max3_u32 v4, v4, v34, v35
  v_max3_u32 v4, v4, v36, v37
  v_max3_u32 v4, v4, v38, v39
  v_max3_u32 v4, v4, v40, v41
  v_max3_u32 v4, v4, v42, v43
  v_max3_u32 v4, v4, v44, v45
  v_max3_u32 v4, v4, v46, v47
  v_max3_u32 v4, v4, v48, v49
  v_max3_u32 v4, v4, v50, v51
  v_max3_u32 v4, v4, v52, v53
  v_max3_u32 v4, v4, v54, v55
  v_max3_u32 v4, v4, v56, v57
  v_max3_u32 v4, v4, v58, v59
  v_max3_u32 v4, v4, v60, v61
  v_max3_u32 v4, v4, v62, v63
  v_cmp_ne_u32 vcc, -1, v4
  s_add_u32 s92, s92, 1
  s_cmp_eq_u64 vcc, exec
  s_cbranch_scc1 Ld_32
  s_sleep 4
  s_cmp_lt_u32 s92, 60000
  s_cbranch_scc1 Lp_31
Ld_32:
  v_add_f32 v32, v32, v36
  v_add_f32 v33, v33, v37
  v_add_f32 v34, v34, v38
  v_add_f32 v35, v35, v39
  v_add_f32 v40, v40, v44
  v_add_f32 v41, v41, v45
  v_add_f32 v42, v42, v46
  v_add_f32 v43, v43, v47
  v_add_f32 v48, v48, v52
  v_add_f32 v49, v49, v53
  v_add_f32 v50, v50, v54
  v_add_f32 v51, v51, v55
  v_add_f32 v56, v56, v60
  v_add_f32 v57, v57, v61
  v_add_f32 v58, v58, v62
  v_add_f32 v59, v59, v63
  v_add_f32 v32, v32, v40
  v_add_f32 v33, v33, v41
  v_add_f32 v34, v34, v42
  v_add_f32 v35, v35, v43
  v_add_f32 v48, v48, v56
  v_add_f32 v49, v49, v57
  v_add_f32 v50, v50, v58
  v_add_f32 v51, v51, v59
  v_add_f32 v32, v32, v48
  v_add_f32 v33, v33, v49
  v_add_f32 v34, v34, v50
  v_add_f32 v35, v35, v51
  v_cvt_pk_bf16_f32 v8, v32, v33
  v_cvt_pk_bf16_f32 v9, v34, v35
  v_lshlrev_b32 v36, 16, v194
  v_and_b32 v37, 0xffff0000, v194
  v_lshlrev_b32 v38, 16, v195
  v_and_b32 v39, 0xffff0000, v195
  v_lshlrev_b32 v32, 16, v8
  v_and_b32 v33, 0xffff0000, v8
  v_lshlrev_b32 v34, 16, v9
  v_and_b32 v35, 0xffff0000, v9
  v_add_f32 v32, v32, v36
  v_add_f32 v33, v33, v37
  v_add_f32 v34, v34, v38
  v_add_f32 v35, v35, v39
  v_cvt_pk_bf16_f32 v8, v32, v33
  v_cvt_pk_bf16_f32 v9, v34, v35
  ds_write_b64 v22, v[8:9] offset:2304
  v_mov_b32 v8, 0
  v_mov_b32 v9, 0
  s_waitcnt lgkmcnt(0)
  s_mov_b64 exec, 1
  ds_add_u32 v192, v193 offset:68
  s_mov_b64 exec, -1
L_dn_e:
Lw_34:
  ds_read_b32 v4, v192 offset:68
  s_waitcnt lgkmcnt(0)
  v_cmp_gt_u32 vcc, 1, v4
  s_cbranch_vccnz Lw_34
  s_mov_b32 s92, 0
Lp_35:
  buffer_load_dwordx4 v[32:35], v18, s[60:63], s93 offen offset:0 sc1
  buffer_load_dwordx4 v[36:39], v18, s[60:63], s93 offen offset:2048 sc1
  buffer_load_dwordx4 v[40:43], v23, s[60:63], s93 offen offset:0 sc1
  buffer_load_dwordx4 v[44:47], v23, s[60:63], s93 offen offset:2048 sc1
  buffer_load_dwordx4 v[48:51], v24, s[60:63], s93 offen offset:0 sc1
  buffer_load_dwordx4 v[52:55], v24, s[60:63], s93 offen offset:2048 sc1
  buffer_load_dwordx4 v[56:59], v18, s[60:63], s94 offen sc1
  s_waitcnt vmcnt(0)
  v_max_u32 v6, v32, v33
  v_max3_u32 v6, v6, v34, v35
  v_max3_u32 v6, v6, v36, v37
  v_max3_u32 v6, v6, v38, v39
  v_max3_u32 v6, v6, v40, v41
  v_max3_u32 v6, v6, v42, v43
  v_max3_u32 v6, v6, v44, v45
  v_max3_u32 v6, v6, v46, v47
  v_max3_u32 v6, v6, v48, v49
  v_max3_u32 v6, v6, v50, v51
  v_max3_u32 v6, v6, v52, v53
  v_max3_u32 v6, v6, v54, v55
  v_max3_u32 v6, v6, v56, v57
  v_max3_u32 v6, v6, v58, v59
  v_cmp_ne_u32 vcc, -1, v6
  s_add_u32 s92, s92, 1
  s_cmp_eq_u64 vcc, exec
  s_cbranch_scc1 Ld_36
  s_sleep 4
  s_cmp_lt_u32 s92, 60000
  s_cbranch_scc1 Lp_35
Ld_36:
  v_mfma_f32_16x16x32_bf16 v[8:11], v[32:35], v[96:99], v[8:11]
  v_mfma_f32_16x16x32_bf16 v[12:15], v[32:35], v[100:103], v[12:15]
  v_mfma_f32_16x16x32_bf16 v[8:11], v[36:39], v[104:107], v[8:11]
  v_mfma_f32_16x16x32_bf16 v[12:15], v[36:39], v[108:111], v[12:15]
  v_mfma_f32_16x16x32_bf16 v[8:11], v[40:43], v[112:115], v[8:11]
  v_mfma_f32_16x16x32_bf16 v[12:15], v[40:43], v[116:119], v[12:15]
  v_mfma_f32_16x16x32_bf16 v[8:11], v[44:47], v[120:123], v[8:11]
  v_mfma_f32_16x16x32_bf16 v[12:15], v[44:47], v[124:127], v[12:15]
  v_mfma_f32_16x16x32_bf16 v[8:11], v[48:51], v[128:131], v[8:11]
  v_mfma_f32_16x16x32_bf16 v[12:15], v[48:51], v[132:135], v[12:15]
  v_mfma_f32_16x16x32_bf16 v[8:11], v[52:55], v[136:139], v[8:11]
  v_mfma_f32_16x16x32_bf16 v[12:15], v[52:55], v[140:143], v[12:15]
  s_cmp_ge_u32 s3, 6
  s_cbranch_scc1 L_dn6
  v_mfma_f32_16x16x32_bf16 v[8:11], v[56:59], v[144:147], v[8:11]
  v_mfma_f32_16x16x32_bf16 v[12:15], v[56:59], v[148:151], v[12:15]
L_dn6:
  s_mov_b64 exec, 0xffff
  s_nop 6
  v_mov_b32 v10, v12
  v_mov_b32 v11, v13
  ds_write_b128 v19, v[8:11] offset:256
  s_mov_b64 exec, -1
  s_waitcnt lgkmcnt(0)
  s_barrier
  s_cmp_lg_u32 s3, 0
  s_cbranch_scc1 L_fin
  v_lshlrev_b32 v16, 4, v3
  v_lshl_add_u32 v16, v2, 2, v16
  v_and_b32 v4, 1, v2
  v_lshrrev_b32 v6, 1, v2
  v_lshlrev_b32 v7, 6, v4
  v_lshl_add_u32 v7, v6, 5, v7
  v_lshl_add_u32 v7, v3, 1, v7
  ds_read_u16 v191, v7 offset:2304
  ds_read_b32 v32, v16 offset:256
  ds_read_b32 v33, v16 offset:512
  ds_read_b32 v34, v16 offset:768
  ds_read_b32 v35, v16 offset:1024
  ds_read_b32 v36, v16 offset:1280
  ds_read_b32 v37, v16 offset:1536
  ds_read_b32 v38, v16 offset:1792
  ds_read_b32 v39, v16 offset:2048
  v_mul_u32_u24 v17, 1280, v4
  v_lshl_add_u32 v17, v6, 5, v17
  v_lshl_add_u32 v17, v3, 1, v17
  v_and_b32 v5, 1, v1
  v_mov_b32 v6, 2147483392
  v_cmp_eq_u32 vcc, 0, v5
  s_lshl_b32 s12, s9, 6
  s_waitcnt lgkmcnt(0)
  v_cndmask_b32 v17, v6, v17, vcc
  v_lshlrev_b32 v191, 16, v191
  v_add_f32 v32, v32, v33
  v_add_f32 v34, v34, v35
  v_add_f32 v36, v36, v37
  v_add_f32 v38, v38, v39
  v_add_f32 v32, v32, v34
  v_add_f32 v36, v36, v38
  v_add_f32 v32, v32, v36
  v_cvt_pk_bf16_f32 v8, v32, v32
  v_lshlrev_b32 v32, 16, v8
  v_add_f32 v32, v32, v191
  s_nop 1
  v_mov_b32_dpp v34, v32 row_ror:15 row_mask:0xf bank_mask:0xf
  v_cvt_pk_bf16_f32 v8, v32, v34
  buffer_store_dword v8, v17, s[52:55], s12 offen
L_fin:
L_end:
  s_endpgm

.section .rodata,"a"
.p2align 6
.amdhsa_kernel sequential_preLN__compressed_kv_cla__glu_gated_swiglu__decode_kernel
  .amdhsa_next_free_vgpr 200
  .amdhsa_next_free_sgpr 102
  .amdhsa_accum_offset 200
  .amdhsa_group_segment_fixed_size 0
  .amdhsa_kernarg_size 104
  .amdhsa_user_sgpr_count 2
  .amdhsa_user_sgpr_kernarg_segment_ptr 1
  .amdhsa_system_sgpr_workgroup_id_x 1
.end_amdhsa_kernel
```
